```python
import torch

def _softmax(x, axis=-1):
    return torch.softmax(x, dim=axis)

def _gelu(x):
    return torch.nn.functional.gelu(x, approximate='tanh')

def _silu(x):
    return torch.nn.functional.silu(x)

def _sigmoid(x):
    return torch.sigmoid(x)

def _layernorm(x, axis=-1, eps=1e-05):
    m = x.mean(dim=axis, keepdim=True)
    v = x.var(dim=axis, keepdim=True, unbiased=False)
    return (x - m) / torch.sqrt(v + eps)

def _scatter_add(tgt, idx, src, axis=0):
    return tgt.clone().index_add_(axis, idx, src)

def _segment_sum(src, seg, n):
    out = torch.zeros((n,) + src.shape[1:], dtype=src.dtype)
    return out.index_add_(0, seg, src)

def _pad(x, pw):
    flat = tuple((v for pair in reversed(pw) for v in pair))
    return torch.nn.functional.pad(x, flat)
kernel_name = 'parallel_sum__linear_attn_block__mixer_gmlp__prompt'

def setup_inputs():

    _w = lambda a: (lambda t: t.to(torch.bfloat16) if t.is_floating_point() else t)(torch.as_tensor(a))

    def _A_setup():
        B, S, D = (1, 2048, 640)
        return {'x': _w((lambda *s: torch.randn(*s, dtype=torch.bfloat16) * 0.05)(B, S, D)), 'wqkv': _w((lambda *s: torch.randn(*s, dtype=torch.bfloat16) * 0.8)(D, 3 * D)), 'wo': _w((lambda *s: torch.randn(*s, dtype=torch.bfloat16) * 0.2)(D, D))}
    _A_in = _A_setup()

    def _B_setup():
        B, S, D, F = (1, 2048, 640, 1536)
        Fh = F // 2
        return {'x': _w((lambda *s: torch.randn(*s, dtype=torch.bfloat16) * 0.05)(B, S, D)), 'w_in': _w((lambda *s: torch.randn(*s, dtype=torch.bfloat16) * 0.4)(D, 2 * Fh)), 'w_sp': _w(0.01 * (lambda *s: torch.randn(*s, dtype=torch.bfloat16) * 0.4)(S, S)), 'b_sp': _w(1.0 + 0.01 * (lambda *s: torch.randn(*s, dtype=torch.bfloat16) * 0.05)(S)), 'w_out': _w((lambda *s: torch.randn(*s, dtype=torch.bfloat16) * 0.05)(Fh, D))}
    _B_in = _B_setup()
    return {'A_x': _A_in['x'], 'A_wqkv': _A_in['wqkv'], 'A_wo': _A_in['wo'], 'B_x': _B_in['x'], 'B_w_in': _B_in['w_in'], 'B_w_sp': _B_in['w_sp'], 'B_b_sp': _B_in['b_sp'], 'B_w_out': _B_in['w_out']}

def reference(A_x, A_wqkv, A_wo, B_x, B_w_in, B_w_sp, B_b_sp, B_w_out):

    def _A_ref(x, wqkv, wo):
        B, S, D = x.shape
        H = 32
        Dh = D // H
        qkv = (lambda x, *d: x.permute(*d))((x @ wqkv).reshape(B, S, 3, H, Dh), 2, 0, 3, 1, 4)
        q, k, v = (qkv[0], qkv[1], qkv[2])
        phi = lambda t: torch.where(t > 0, t + 1, torch.exp(t)) + 1e-06
        pq, pk = (phi(q), phi(k))
        kv = torch.einsum('bhsd,bhse->bhde', pk, v)
        z = torch.einsum('bhsd->bhd', pk)
        num = torch.einsum('bhqd,bhde->bhqe', pq, kv)
        den = torch.einsum('bhqd,bhd->bhq', pq, z)[..., None] + 1e-06
        o = num / den
        return (lambda x, *d: x.permute(*d))(o, 0, 2, 1, 3).reshape(B, S, D) @ wo

    def _B_ref(x, w_in, w_sp, b_sp, w_out):
        B, S, D = x.shape
        F = w_in.shape[-1]
        Fh = F // 2
        z = _gelu(torch.einsum('bsd,df->bsf', x, w_in))
        z1 = z[..., :Fh].clone()
        z2 = _layernorm(z[..., Fh:], axis=-1)
        g = torch.einsum('ts,bsf->btf', w_sp, z2) + b_sp[None, :, None]
        return torch.einsum('bsf,fd->bsd', z1 * g, w_out)
    x = A_x
    xn = _layernorm(x, axis=-1)
    return x + _A_ref(xn, A_wqkv, A_wo) + _B_ref(xn, B_w_in, B_w_sp, B_b_sp, B_w_out)
```

```asm
; @launch kernel=k1_kernel grid=(256,1,1) block=(512,1,1) lds=150528
; @launch kernel=k2_kernel grid=(256,1,1) block=(448,1,1) lds=156672
; @launch kernel=k3_kernel grid=(256,1,1) block=(256,1,1) lds=81920
.amdgcn_target "amdgcn-amd-amdhsa--gfx950"
.text
.globl k1_kernel
.p2align 8
.type k1_kernel,@function
k1_kernel:
    s_cmp_ge_u32 s2, 256
    s_cbranch_scc1 K1_END
    s_cmp_ge_u32 s2, 224
    s_cbranch_scc1 K1_PF
    s_load_dwordx2 s[4:5], s[0:1], 0
    s_load_dwordx2 s[6:7], s[0:1], 8
    s_load_dwordx2 s[8:9], s[0:1], 32
    s_load_dwordx2 s[10:11], s[0:1], 80
    s_and_b32 s36, s2, 3
    s_lshl_b32 s36, s36, 2
    s_bfe_u32 s37, s2, 0x20003
    s_add_u32 s24, s36, s37
    s_bfe_u32 s36, s2, 0x10002
    s_mul_i32 s36, s36, 7
    s_lshr_b32 s37, s2, 5
    s_add_u32 s25, s36, s37
    v_lshrrev_b32 v4, 6, v0
    v_and_b32 v1, 63, v0
    v_and_b32 v2, 15, v0
    v_readfirstlane_b32 s26, v4
    v_lshrrev_b32 v3, 4, v1
    s_cmp_lg_u32 s25, 0
    s_cbranch_scc1 K1_J_1
    s_mov_b32 s38, 1094721824
K1_J_1:
    s_cmp_lg_u32 s25, 1
    s_cbranch_scc1 K1_J_2
    s_mov_b32 s38, 1128407842
K1_J_2:
    s_cmp_lg_u32 s25, 2
    s_cbranch_scc1 K1_J_3
    s_mov_b32 s38, 1162093860
K1_J_3:
    s_cmp_lg_u32 s25, 3
    s_cbranch_scc1 K1_J_4
    s_mov_b32 s38, 1195779878
K1_J_4:
    s_cmp_lg_u32 s25, 4
    s_cbranch_scc1 K1_J_5
    s_mov_b32 s38, 1229465896
K1_J_5:
    s_cmp_lg_u32 s25, 5
    s_cbranch_scc1 K1_J_6
    s_mov_b32 s38, 155846698
K1_J_6:
    s_cmp_lg_u32 s25, 6
    s_cbranch_scc1 K1_J_7
    s_mov_b32 s38, 50462976
K1_J_7:
    s_cmp_lg_u32 s25, 7
    s_cbranch_scc1 K1_J_8
    s_mov_b32 s38, 117835012
K1_J_8:
    s_cmp_lg_u32 s25, 8
    s_cbranch_scc1 K1_J_9
    s_mov_b32 s38, 1667391840
K1_J_9:
    s_cmp_lg_u32 s25, 9
    s_cbranch_scc1 K1_J_10
    s_mov_b32 s38, 1734763876
K1_J_10:
    s_cmp_lg_u32 s25, 10
    s_cbranch_scc1 K1_J_11
    s_mov_b32 s38, 1802135912
K1_J_11:
    s_cmp_lg_u32 s25, 11
    s_cbranch_scc1 K1_J_12
    s_mov_b32 s38, 2206368128
K1_J_12:
    s_cmp_lg_u32 s25, 12
    s_cbranch_scc1 K1_J_13
    s_mov_b32 s38, 2273740164
K1_J_13:
    s_cmp_lg_u32 s25, 13
    s_cbranch_scc1 K1_J_14
    s_mov_b32 s38, 2341112200
K1_J_14:
    s_lshr_b32 s29, s26, 2
    s_and_b32 s30, s26, 3
    s_lshl_b32 s36, s30, 3
    s_lshr_b32 s36, s38, s36
    s_and_b32 s28, s36, 31
    s_bfe_u32 s27, s36, 0x30005
    s_lshr_b32 s39, s26, 1
    s_lshl_b32 s36, s39, 3
    s_lshr_b32 s36, s38, s36
    s_and_b32 s40, s36, 31
    s_bfe_u32 s41, s36, 0x30005
    s_lshl_b32 s36, s40, 7
    s_mul_i32 s37, s40, 120
    s_mov_b32 s32, s36
    s_add_u32 s42, s37, 1280
    s_cmp_eq_u32 s41, 1
    s_cselect_b32 s32, s42, s32
    s_add_u32 s42, s37, 2560
    s_cmp_eq_u32 s41, 2
    s_cselect_b32 s32, s42, s32
    s_add_u32 s42, s36, 1536
    s_cmp_eq_u32 s41, 4
    s_cselect_b32 s32, s42, s32
    s_cmp_lt_u32 s41, 3
    s_movk_i32 s33, 3072
    s_cselect_b32 s33, 3840, s33
    v_lshrrev_b32 v4, 3, v1
    v_and_b32 v5, 7, v1
    v_bfe_u32 v6, v4, 1, 1
    v_xor_b32 v6, v5, v6
    v_mul_lo_u32 v7, v4, s33
    v_lshl_add_u32 v9, v6, 4, v7
    s_and_b32 s36, s26, 1
    s_lshl_b32 s36, s36, 5
    s_mul_i32 s36, s36, s33
    s_add_u32 s32, s32, s36
    s_lshl_b32 s36, s30, 1
    v_bfe_u32 v6, v4, 1, 1
    v_or_b32 v6, s36, v6
    v_xor_b32 v6, v5, v6
    v_mul_u32_u24 v7, 1280, v4
    v_lshl_add_u32 v8, v6, 4, v7
    s_lshl_b32 s36, s24, 7
    s_lshl_b32 s37, s26, 4
    s_add_u32 s36, s36, s37
    s_mul_i32 s31, s36, 1280
    s_lshl_b32 s34, s26, 11
    s_lshl_b32 s35, s26, 12
    s_add_u32 s35, s35, 16384
    s_waitcnt lgkmcnt(0)
    s_mov_b32 s12, s4
    s_and_b32 s13, s5, 0xffff
    s_mov_b32 s14, 2621440
    s_mov_b32 s15, 0x00020000
    s_mov_b32 s20, s10
    s_and_b32 s21, s11, 0xffff
    s_mov_b32 s22, 21987328
    s_mov_b32 s23, 0x00020000
    s_and_b32 s7, s7, 0xffff
    s_and_b32 s9, s9, 0xffff
    s_cmp_lt_u32 s41, 3
    s_cselect_b32 s16, s6, s8
    s_cselect_b32 s17, s7, s9
    s_mov_b32 s18, 1966080
    s_cselect_b32 s18, 2457600, s18
    s_mov_b32 s19, 0x00020000
    s_lshl_b32 s43, s33, 3
    s_lshl_b32 s44, s33, 6
    s_add_u32 m0, s34, 0
    s_add_u32 s45, s31, 0
    buffer_load_dwordx4 v8, s[12:15], s45 offen lds
    s_add_u32 m0, s34, 1024
    s_add_u32 s45, s31, 10240
    buffer_load_dwordx4 v8, s[12:15], s45 offen lds
    s_mov_b32 s45, s32
    s_add_u32 m0, s35, 0
    s_nop 0
    buffer_load_dwordx4 v9, s[16:19], s45 offen lds
    s_add_u32 m0, s35, 1024
    s_add_u32 s45, s45, s43
    buffer_load_dwordx4 v9, s[16:19], s45 offen lds
    s_add_u32 m0, s35, 2048
    s_add_u32 s45, s45, s43
    buffer_load_dwordx4 v9, s[16:19], s45 offen lds
    s_add_u32 m0, s35, 3072
    s_add_u32 s45, s45, s43
    buffer_load_dwordx4 v9, s[16:19], s45 offen lds
    s_add_u32 s32, s32, s44
    s_add_u32 m0, s34, 49152
    s_add_u32 s45, s31, 128
    buffer_load_dwordx4 v8, s[12:15], s45 offen lds
    s_add_u32 m0, s34, 50176
    s_add_u32 s45, s31, 10368
    buffer_load_dwordx4 v8, s[12:15], s45 offen lds
    s_mov_b32 s45, s32
    s_add_u32 m0, s35, 49152
    s_nop 0
    buffer_load_dwordx4 v9, s[16:19], s45 offen lds
    s_add_u32 m0, s35, 50176
    s_add_u32 s45, s45, s43
    buffer_load_dwordx4 v9, s[16:19], s45 offen lds
    s_add_u32 m0, s35, 51200
    s_add_u32 s45, s45, s43
    buffer_load_dwordx4 v9, s[16:19], s45 offen lds
    s_add_u32 m0, s35, 52224
    s_add_u32 s45, s45, s43
    buffer_load_dwordx4 v9, s[16:19], s45 offen lds
    s_add_u32 s32, s32, s44
    v_mul_u32_u24 v120, 1280, v2
    v_and_b32 v4, 31, v1
    v_mul_lo_u32 v121, v4, s33
    v_lshrrev_b32 v4, 5, v1
    v_mul_u32_u24 v4, 124, v4
    v_add_u32 v121, v121, v4
    v_lshlrev_b32 v4, 2, v0
    v_add_u32 v4, 149504, v4
    v_mov_b32 v5, 0
    v_cmp_gt_u32 vcc, 256, v0
    s_and_saveexec_b64 s[46:47], vcc
    ds_write_b32 v4, v5
    s_mov_b64 exec, s[46:47]
    v_lshrrev_b32 v4, 2, v2
    v_lshlrev_b32 v4, 4, v4
    v_and_b32 v5, 3, v2
    v_add_u32 v4, v4, v5
    s_lshl_b32 s36, s29, 6
    v_add_u32 v4, s36, v4
    v_lshlrev_b32 v4, 7, v4
    v_lshrrev_b32 v5, 1, v2
    v_xor_b32 v5, v5, v3
    v_lshl_add_u32 v11, v5, 4, v4
    v_bfe_u32 v4, v1, 2, 2
    v_and_b32 v5, 3, v1
    v_lshl_add_u32 v6, v3, 3, v4
    v_lshlrev_b32 v6, 7, v6
    s_lshl_b32 s36, s30, 13
    s_add_u32 s36, s36, 16384
    v_add_u32 v6, s36, v6
    v_lshrrev_b32 v4, 1, v4
    v_xor_b32 v4, s29, v4
    v_lshlrev_b32 v7, 1, v5
    v_xor_b32 v7, v7, v4
    v_lshl_add_u32 v12, v7, 4, v6
    v_lshlrev_b32 v7, 1, v5
    v_xor_b32 v7, v7, v4
    v_lshl_add_u32 v13, v7, 4, v6
    v_add_u32 v13, 8, v13
    v_lshlrev_b32 v7, 1, v5
    v_or_b32 v7, 1, v7
    v_xor_b32 v7, v7, v4
    v_lshl_add_u32 v14, v7, 4, v6
    v_lshlrev_b32 v7, 1, v5
    v_or_b32 v7, 1, v7
    v_xor_b32 v7, v7, v4
    v_lshl_add_u32 v15, v7, 4, v6
    v_add_u32 v15, 8, v15
    v_mov_b32 v24, 0x3f803f80
    v_mov_b32 v25, 0x3f803f80
    v_mov_b32 v26, 0x3f803f80
    v_mov_b32 v27, 0x3f803f80
    v_mov_b32 v28, 0
    v_mov_b32 v29, 0
    v_mov_b32 v30, 0
    v_mov_b32 v31, 0
    s_mov_b32 s48, 0xffff0000
    v_mov_b32 v192, 0
    v_mov_b32 v193, 0
    v_mov_b32 v194, 0
    v_mov_b32 v195, 0
    v_mov_b32 v196, 0
    v_mov_b32 v197, 0
    v_mov_b32 v198, 0
    v_mov_b32 v199, 0
    v_mov_b32 v200, 0
    v_mov_b32 v201, 0
    v_mov_b32 v202, 0
    v_mov_b32 v203, 0
    v_mov_b32 v204, 0
    v_mov_b32 v205, 0
    v_mov_b32 v206, 0
    v_mov_b32 v207, 0
    v_mov_b32 v208, 0
    v_mov_b32 v209, 0
    v_mov_b32 v210, 0
    v_mov_b32 v211, 0
    v_mov_b32 v212, 0
    v_mov_b32 v213, 0
    v_mov_b32 v214, 0
    v_mov_b32 v215, 0
    v_mov_b32 v216, 0
    v_mov_b32 v217, 0
    v_mov_b32 v218, 0
    v_mov_b32 v219, 0
    v_mov_b32 v220, 0
    v_mov_b32 v221, 0
    v_mov_b32 v222, 0
    v_mov_b32 v223, 0
    v_mov_b32 v224, 0
    v_mov_b32 v225, 0
    v_mov_b32 v226, 0
    v_mov_b32 v227, 0
    v_mov_b32 v228, 0
    v_mov_b32 v229, 0
    v_mov_b32 v230, 0
    v_mov_b32 v231, 0
    v_mov_b32 v232, 0
    v_mov_b32 v233, 0
    v_mov_b32 v234, 0
    v_mov_b32 v235, 0
    v_mov_b32 v236, 0
    v_mov_b32 v237, 0
    v_mov_b32 v238, 0
    v_mov_b32 v239, 0
    v_mov_b32 v240, 0
    v_mov_b32 v241, 0
    v_mov_b32 v242, 0
    v_mov_b32 v243, 0
    v_mov_b32 v244, 0
    v_mov_b32 v245, 0
    v_mov_b32 v246, 0
    v_mov_b32 v247, 0
    v_mov_b32 v248, 0
    v_mov_b32 v249, 0
    v_mov_b32 v250, 0
    v_mov_b32 v251, 0
    v_mov_b32 v252, 0
    v_mov_b32 v253, 0
    v_mov_b32 v254, 0
    v_mov_b32 v255, 0
    v_mov_b32 v104, 0
    v_mov_b32 v105, 0
    v_mov_b32 v106, 0
    v_mov_b32 v107, 0
    v_mov_b32 v108, 0
    v_mov_b32 v109, 0
    v_mov_b32 v110, 0
    v_mov_b32 v111, 0
    v_mov_b32 v56, 0
    v_mov_b32 v57, 0
    v_mov_b32 v58, 0
    v_mov_b32 v59, 0
    v_mov_b32 v60, 0
    v_mov_b32 v61, 0
    v_mov_b32 v62, 0
    v_mov_b32 v63, 0
    v_mov_b32 v64, 0
    v_mov_b32 v65, 0
    v_mov_b32 v66, 0
    v_mov_b32 v67, 0
    v_mov_b32 v68, 0
    v_mov_b32 v69, 0
    v_mov_b32 v70, 0
    v_mov_b32 v71, 0
    v_mov_b32 v88, 0
    v_mov_b32 v89, 0
    v_mov_b32 v90, 0
    v_mov_b32 v91, 0
    v_mov_b32 v92, 0
    v_mov_b32 v93, 0
    v_mov_b32 v94, 0
    v_mov_b32 v95, 0
    v_mov_b32 v96, 0
    v_mov_b32 v97, 0
    v_mov_b32 v98, 0
    v_mov_b32 v99, 0
    v_mov_b32 v100, 0
    v_mov_b32 v101, 0
    v_mov_b32 v102, 0
    v_mov_b32 v103, 0
    v_mov_b32 v116, 0
    v_mov_b32 v117, 0
    v_mov_b32 v118, 0
    v_mov_b32 v119, 0
    s_mov_b32 s49, 0
    s_mov_b32 s50, 0
    s_mov_b32 s51, 98304
    s_lshl_b32 s52, s30, 9
    s_add_u32 s31, s31, 256
    s_cmp_eq_u32 s27, 0
    s_cbranch_scc1 K1_MAIN_N
    s_cmp_eq_u32 s27, 3
    s_cbranch_scc1 K1_MAIN_N
    s_branch K1_MAIN_T
K1_MAIN_N:
K1_LOOP_15:
    s_cmp_lt_u32 s49, 9
    s_cbranch_scc1 K1_NW_17
    s_waitcnt vmcnt(0)
K1_NW_17:
    s_waitcnt vmcnt(6) lgkmcnt(0)
    s_barrier
    v_add_u32 v16, s50, v11
    v_xor_b32 v17, 64, v16
    v_add_u32 v22, s52, v16
    v_xor_b32 v23, 64, v22
    v_add_u32 v18, s50, v12
    v_add_u32 v19, s50, v13
    v_add_u32 v20, s50, v14
    v_add_u32 v21, s50, v15
    s_cmp_lt_u32 s49, 8
    s_cbranch_scc0 K1_ND_16
    v_mfma_f32_16x16x32_bf16 v[192:195], v[88:91], v[56:59], v[192:195]
    ds_read_b128 v[40:43], v16 offset:0
    v_lshlrev_b32 v32, 16, v116
    v_and_b32 v33, s48, v116
    v_mfma_f32_16x16x32_bf16 v[196:199], v[88:91], v[60:63], v[196:199]
    ds_read_b128 v[44:47], v16 offset:512
    v_lshlrev_b32 v34, 16, v117
    v_and_b32 v35, s48, v117
    v_mfma_f32_16x16x32_bf16 v[200:203], v[88:91], v[64:67], v[200:203]
    ds_read_b128 v[48:51], v16 offset:1024
    v_lshlrev_b32 v36, 16, v118
    v_and_b32 v37, s48, v118
    v_mfma_f32_16x16x32_bf16 v[204:207], v[88:91], v[68:71], v[204:207]
    ds_read_b128 v[52:55], v16 offset:1536
    v_lshlrev_b32 v38, 16, v119
    v_and_b32 v39, s48, v119
    v_mfma_f32_16x16x32_bf16 v[208:211], v[92:95], v[56:59], v[208:211]
    ds_read_b64_tr_b16 v[72:73], v18 offset:0
    v_add_f32 v28, v28, v32
    v_fmac_f32 v30, v32, v32
    v_mfma_f32_16x16x32_bf16 v[212:215], v[92:95], v[60:63], v[212:215]
    ds_read_b64_tr_b16 v[74:75], v18 offset:512
    v_add_f32 v29, v29, v33
    v_fmac_f32 v31, v33, v33
    v_mfma_f32_16x16x32_bf16 v[216:219], v[92:95], v[64:67], v[216:219]
    ds_read_b64_tr_b16 v[76:77], v19 offset:0
    v_add_f32 v28, v28, v34
    v_fmac_f32 v30, v34, v34
    v_mfma_f32_16x16x32_bf16 v[220:223], v[92:95], v[68:71], v[220:223]
    ds_read_b64_tr_b16 v[78:79], v19 offset:512
    v_add_f32 v29, v29, v35
    v_fmac_f32 v31, v35, v35
    v_mfma_f32_16x16x32_bf16 v[224:227], v[96:99], v[56:59], v[224:227]
    ds_read_b64_tr_b16 v[80:81], v20 offset:0
    v_add_f32 v28, v28, v36
    v_fmac_f32 v30, v36, v36
    v_mfma_f32_16x16x32_bf16 v[228:231], v[96:99], v[60:63], v[228:231]
    ds_read_b64_tr_b16 v[82:83], v20 offset:512
    v_add_f32 v29, v29, v37
    v_fmac_f32 v31, v37, v37
    v_mfma_f32_16x16x32_bf16 v[232:235], v[96:99], v[64:67], v[232:235]
    ds_read_b64_tr_b16 v[84:85], v21 offset:0
    v_add_f32 v28, v28, v38
    v_fmac_f32 v30, v38, v38
    v_mfma_f32_16x16x32_bf16 v[236:239], v[96:99], v[68:71], v[236:239]
    ds_read_b64_tr_b16 v[86:87], v21 offset:512
    v_add_f32 v29, v29, v39
    v_fmac_f32 v31, v39, v39
    v_mfma_f32_16x16x32_bf16 v[240:243], v[100:103], v[56:59], v[240:243]
    ds_read_b128 v[112:115], v22
    s_add_u32 s46, s34, s51
    s_add_u32 m0, s46, 0
    s_add_u32 s45, s31, 0
    buffer_load_dwordx4 v8, s[12:15], s45 offen lds
    v_mfma_f32_16x16x32_bf16 v[244:247], v[100:103], v[60:63], v[244:247]
    s_add_u32 s46, s34, s51
    s_add_u32 m0, s46, 1024
    s_add_u32 s45, s31, 10240
    buffer_load_dwordx4 v8, s[12:15], s45 offen lds
    v_mfma_f32_16x16x32_bf16 v[248:251], v[100:103], v[64:67], v[248:251]
    s_add_u32 s46, s35, s51
    s_add_u32 m0, s46, 0
    s_mov_b32 s47, s32
    buffer_load_dwordx4 v9, s[16:19], s47 offen lds
    v_mfma_f32_16x16x32_bf16 v[252:255], v[100:103], v[68:71], v[252:255]
    s_add_u32 s46, s35, s51
    s_add_u32 m0, s46, 1024
    s_add_u32 s47, s47, s43
    buffer_load_dwordx4 v9, s[16:19], s47 offen lds
    v_mfma_f32_16x16x32_bf16 v[104:107], v[88:91], v[24:27], v[104:107]
    s_add_u32 s46, s35, s51
    s_add_u32 m0, s46, 2048
    s_add_u32 s47, s47, s43
    buffer_load_dwordx4 v9, s[16:19], s47 offen lds
    v_mfma_f32_16x16x32_bf16 v[108:111], v[92:95], v[24:27], v[108:111]
    s_add_u32 s46, s35, s51
    s_add_u32 m0, s46, 3072
    s_add_u32 s47, s47, s43
    buffer_load_dwordx4 v9, s[16:19], s47 offen lds
    s_add_u32 s32, s32, s44
    s_add_u32 s31, s31, 128
    s_branch K1_J2_18
K1_ND_16:
    v_mfma_f32_16x16x32_bf16 v[192:195], v[88:91], v[56:59], v[192:195]
    ds_read_b128 v[40:43], v16 offset:0
    v_lshlrev_b32 v32, 16, v116
    v_and_b32 v33, s48, v116
    v_mfma_f32_16x16x32_bf16 v[196:199], v[88:91], v[60:63], v[196:199]
    ds_read_b128 v[44:47], v16 offset:512
    v_lshlrev_b32 v34, 16, v117
    v_and_b32 v35, s48, v117
    v_mfma_f32_16x16x32_bf16 v[200:203], v[88:91], v[64:67], v[200:203]
    ds_read_b128 v[48:51], v16 offset:1024
    v_lshlrev_b32 v36, 16, v118
    v_and_b32 v37, s48, v118
    v_mfma_f32_16x16x32_bf16 v[204:207], v[88:91], v[68:71], v[204:207]
    ds_read_b128 v[52:55], v16 offset:1536
    v_lshlrev_b32 v38, 16, v119
    v_and_b32 v39, s48, v119
    v_mfma_f32_16x16x32_bf16 v[208:211], v[92:95], v[56:59], v[208:211]
    ds_read_b64_tr_b16 v[72:73], v18 offset:0
    v_add_f32 v28, v28, v32
    v_fmac_f32 v30, v32, v32
    v_mfma_f32_16x16x32_bf16 v[212:215], v[92:95], v[60:63], v[212:215]
    ds_read_b64_tr_b16 v[74:75], v18 offset:512
    v_add_f32 v29, v29, v33
    v_fmac_f32 v31, v33, v33
    v_mfma_f32_16x16x32_bf16 v[216:219], v[92:95], v[64:67], v[216:219]
    ds_read_b64_tr_b16 v[76:77], v19 offset:0
    v_add_f32 v28, v28, v34
    v_fmac_f32 v30, v34, v34
    v_mfma_f32_16x16x32_bf16 v[220:223], v[92:95], v[68:71], v[220:223]
    ds_read_b64_tr_b16 v[78:79], v19 offset:512
    v_add_f32 v29, v29, v35
    v_fmac_f32 v31, v35, v35
    v_mfma_f32_16x16x32_bf16 v[224:227], v[96:99], v[56:59], v[224:227]
    ds_read_b64_tr_b16 v[80:81], v20 offset:0
    v_add_f32 v28, v28, v36
    v_fmac_f32 v30, v36, v36
    v_mfma_f32_16x16x32_bf16 v[228:231], v[96:99], v[60:63], v[228:231]
    ds_read_b64_tr_b16 v[82:83], v20 offset:512
    v_add_f32 v29, v29, v37
    v_fmac_f32 v31, v37, v37
    v_mfma_f32_16x16x32_bf16 v[232:235], v[96:99], v[64:67], v[232:235]
    ds_read_b64_tr_b16 v[84:85], v21 offset:0
    v_add_f32 v28, v28, v38
    v_fmac_f32 v30, v38, v38
    v_mfma_f32_16x16x32_bf16 v[236:239], v[96:99], v[68:71], v[236:239]
    ds_read_b64_tr_b16 v[86:87], v21 offset:512
    v_add_f32 v29, v29, v39
    v_fmac_f32 v31, v39, v39
    v_mfma_f32_16x16x32_bf16 v[240:243], v[100:103], v[56:59], v[240:243]
    ds_read_b128 v[112:115], v22
    v_mfma_f32_16x16x32_bf16 v[244:247], v[100:103], v[60:63], v[244:247]
    v_mfma_f32_16x16x32_bf16 v[248:251], v[100:103], v[64:67], v[248:251]
    v_mfma_f32_16x16x32_bf16 v[252:255], v[100:103], v[68:71], v[252:255]
    v_mfma_f32_16x16x32_bf16 v[104:107], v[88:91], v[24:27], v[104:107]
    v_mfma_f32_16x16x32_bf16 v[108:111], v[92:95], v[24:27], v[108:111]
K1_J2_18:
    s_waitcnt lgkmcnt(0)
    v_mfma_f32_16x16x32_bf16 v[192:195], v[72:75], v[40:43], v[192:195]
    ds_read_b128 v[56:59], v17 offset:0
    v_lshlrev_b32 v32, 16, v112
    v_and_b32 v33, s48, v112
    v_mfma_f32_16x16x32_bf16 v[196:199], v[72:75], v[44:47], v[196:199]
    ds_read_b128 v[60:63], v17 offset:512
    v_lshlrev_b32 v34, 16, v113
    v_and_b32 v35, s48, v113
    v_mfma_f32_16x16x32_bf16 v[200:203], v[72:75], v[48:51], v[200:203]
    ds_read_b128 v[64:67], v17 offset:1024
    v_lshlrev_b32 v36, 16, v114
    v_and_b32 v37, s48, v114
    v_mfma_f32_16x16x32_bf16 v[204:207], v[72:75], v[52:55], v[204:207]
    ds_read_b128 v[68:71], v17 offset:1536
    v_lshlrev_b32 v38, 16, v115
    v_and_b32 v39, s48, v115
    v_mfma_f32_16x16x32_bf16 v[208:211], v[76:79], v[40:43], v[208:211]
    ds_read_b64_tr_b16 v[88:89], v18 offset:4096
    v_add_f32 v28, v28, v32
    v_fmac_f32 v30, v32, v32
    v_mfma_f32_16x16x32_bf16 v[212:215], v[76:79], v[44:47], v[212:215]
    ds_read_b64_tr_b16 v[90:91], v18 offset:4608
    v_add_f32 v29, v29, v33
    v_fmac_f32 v31, v33, v33
    v_mfma_f32_16x16x32_bf16 v[216:219], v[76:79], v[48:51], v[216:219]
    ds_read_b64_tr_b16 v[92:93], v19 offset:4096
    v_add_f32 v28, v28, v34
    v_fmac_f32 v30, v34, v34
    v_mfma_f32_16x16x32_bf16 v[220:223], v[76:79], v[52:55], v[220:223]
    ds_read_b64_tr_b16 v[94:95], v19 offset:4608
    v_add_f32 v29, v29, v35
    v_fmac_f32 v31, v35, v35
    v_mfma_f32_16x16x32_bf16 v[224:227], v[80:83], v[40:43], v[224:227]
    ds_read_b64_tr_b16 v[96:97], v20 offset:4096
    v_add_f32 v28, v28, v36
    v_fmac_f32 v30, v36, v36
    v_mfma_f32_16x16x32_bf16 v[228:231], v[80:83], v[44:47], v[228:231]
    ds_read_b64_tr_b16 v[98:99], v20 offset:4608
    v_add_f32 v29, v29, v37
    v_fmac_f32 v31, v37, v37
    v_mfma_f32_16x16x32_bf16 v[232:235], v[80:83], v[48:51], v[232:235]
    ds_read_b64_tr_b16 v[100:101], v21 offset:4096
    v_add_f32 v28, v28, v38
    v_fmac_f32 v30, v38, v38
    v_mfma_f32_16x16x32_bf16 v[236:239], v[80:83], v[52:55], v[236:239]
    ds_read_b64_tr_b16 v[102:103], v21 offset:4608
    v_add_f32 v29, v29, v39
    v_fmac_f32 v31, v39, v39
    v_mfma_f32_16x16x32_bf16 v[240:243], v[84:87], v[40:43], v[240:243]
    ds_read_b128 v[116:119], v23
    v_mfma_f32_16x16x32_bf16 v[244:247], v[84:87], v[44:47], v[244:247]
    v_mfma_f32_16x16x32_bf16 v[248:251], v[84:87], v[48:51], v[248:251]
    v_mfma_f32_16x16x32_bf16 v[252:255], v[84:87], v[52:55], v[252:255]
    v_mfma_f32_16x16x32_bf16 v[104:107], v[72:75], v[24:27], v[104:107]
    v_mfma_f32_16x16x32_bf16 v[108:111], v[76:79], v[24:27], v[108:111]
    s_mov_b32 s51, s50
    s_add_u32 s50, s50, 49152
    s_cmp_eq_u32 s50, 147456
    s_cselect_b32 s50, 0, s50
    s_add_u32 s49, s49, 1
    s_cmp_lt_u32 s49, 10
    s_cbranch_scc1 K1_LOOP_15
    s_waitcnt lgkmcnt(0)
    v_mfma_f32_16x16x32_bf16 v[192:195], v[88:91], v[56:59], v[192:195]
    v_lshlrev_b32 v32, 16, v116
    v_and_b32 v33, s48, v116
    v_mfma_f32_16x16x32_bf16 v[196:199], v[88:91], v[60:63], v[196:199]
    v_lshlrev_b32 v34, 16, v117
    v_and_b32 v35, s48, v117
    v_mfma_f32_16x16x32_bf16 v[200:203], v[88:91], v[64:67], v[200:203]
    v_lshlrev_b32 v36, 16, v118
    v_and_b32 v37, s48, v118
    v_mfma_f32_16x16x32_bf16 v[204:207], v[88:91], v[68:71], v[204:207]
    v_lshlrev_b32 v38, 16, v119
    v_and_b32 v39, s48, v119
    v_mfma_f32_16x16x32_bf16 v[208:211], v[92:95], v[56:59], v[208:211]
    v_add_f32 v28, v28, v32
    v_fmac_f32 v30, v32, v32
    v_mfma_f32_16x16x32_bf16 v[212:215], v[92:95], v[60:63], v[212:215]
    v_add_f32 v29, v29, v33
    v_fmac_f32 v31, v33, v33
    v_mfma_f32_16x16x32_bf16 v[216:219], v[92:95], v[64:67], v[216:219]
    v_add_f32 v28, v28, v34
    v_fmac_f32 v30, v34, v34
    v_mfma_f32_16x16x32_bf16 v[220:223], v[92:95], v[68:71], v[220:223]
    v_add_f32 v29, v29, v35
    v_fmac_f32 v31, v35, v35
    v_mfma_f32_16x16x32_bf16 v[224:227], v[96:99], v[56:59], v[224:227]
    v_add_f32 v28, v28, v36
    v_fmac_f32 v30, v36, v36
    v_mfma_f32_16x16x32_bf16 v[228:231], v[96:99], v[60:63], v[228:231]
    v_add_f32 v29, v29, v37
    v_fmac_f32 v31, v37, v37
    v_mfma_f32_16x16x32_bf16 v[232:235], v[96:99], v[64:67], v[232:235]
    v_add_f32 v28, v28, v38
    v_fmac_f32 v30, v38, v38
    v_mfma_f32_16x16x32_bf16 v[236:239], v[96:99], v[68:71], v[236:239]
    v_add_f32 v29, v29, v39
    v_fmac_f32 v31, v39, v39
    v_mfma_f32_16x16x32_bf16 v[240:243], v[100:103], v[56:59], v[240:243]
    v_mfma_f32_16x16x32_bf16 v[244:247], v[100:103], v[60:63], v[244:247]
    v_mfma_f32_16x16x32_bf16 v[248:251], v[100:103], v[64:67], v[248:251]
    v_mfma_f32_16x16x32_bf16 v[252:255], v[100:103], v[68:71], v[252:255]
    v_mfma_f32_16x16x32_bf16 v[104:107], v[88:91], v[24:27], v[104:107]
    v_mfma_f32_16x16x32_bf16 v[108:111], v[92:95], v[24:27], v[108:111]
    s_nop 7
    v_add_f32 v28, v28, v29
    v_add_f32 v29, v30, v31
    v_xor_b32 v4, 16, v1
    v_lshlrev_b32 v4, 2, v4
    v_xor_b32 v5, 32, v1
    v_lshlrev_b32 v5, 2, v5
    ds_bpermute_b32 v6, v4, v28
    ds_bpermute_b32 v7, v4, v29
    s_waitcnt lgkmcnt(0)
    v_add_f32 v28, v28, v6
    v_add_f32 v29, v29, v7
    ds_bpermute_b32 v6, v5, v28
    ds_bpermute_b32 v7, v5, v29
    s_waitcnt lgkmcnt(0)
    v_add_f32 v28, v28, v6
    v_add_f32 v29, v29, v7
    s_mov_b32 s36, 0x3acccccd
    s_mov_b32 s37, 0x3727c5ac
    v_mul_f32 v28, s36, v28
    v_mul_f32 v29, s36, v29
    v_fma_f32 v29, -v28, v28, v29
    v_max_f32 v29, 0, v29
    v_add_f32 v29, s37, v29
    v_rsq_f32 v30, v29
    s_nop 0
    v_mul_f32 v31, v28, v30
    v_lshrrev_b32 v4, 7, v11
    s_lshl_b32 s36, s30, 2
    v_add_u32 v4, s36, v4
    v_lshlrev_b32 v4, 3, v4
    v_add_u32 v4, 147456, v4
    ds_write_b64 v4, v[30:31]
    s_lshl_b32 s36, s30, 8
    s_lshl_b32 s37, s29, 5
    s_add_u32 s36, s36, s37
    s_add_u32 s36, s36, 148480
    v_lshlrev_b32 v4, 6, v3
    v_add_u32 v4, s36, v4
    ds_write_b128 v4, v[104:107]
    ds_write_b128 v4, v[108:111] offset:16
    s_waitcnt lgkmcnt(0)
    s_barrier
    s_mov_b32 s40, 0x3fb8aa3b
    s_mov_b32 s41, 0x358637bd
    s_mov_b32 s42, 0xbdd2d3e8
    v_mov_b32 v4, 0xc0135761
    v_lshrrev_b32 v5, 7, v11
    v_lshlrev_b32 v6, 3, v5
    v_add_u32 v10, 147456, v6
    s_lshl_b32 s36, s30, 8
    s_add_u32 s36, s36, 148480
    v_lshlrev_b32 v6, 6, v3
    v_add_u32 v6, s36, v6
    s_lshl_b32 s37, s29, 5
    v_add_u32 v7, s37, v6
    v_xor_b32 v8, 32, v7
    ds_read_b128 v[144:147], v7 offset:0
    ds_read_b128 v[148:151], v7 offset:16
    ds_read_b128 v[152:155], v8 offset:0
    ds_read_b128 v[156:159], v8 offset:16
    s_cmp_eq_u32 s27, 0
    s_movk_i32 s43, 1536
    s_cselect_b32 s43, 1280, s43
    s_cselect_b32 s44, 0, 7864320
    s_lshl_b32 s45, s28, 7
    s_add_u32 s44, s44, s45
    s_lshl_b32 s45, s24, 7
    v_add_u32 v5, s45, v5
    v_mul_lo_u32 v5, v5, s43
    v_lshl_add_u32 v5, v3, 5, v5
    s_lshl_b32 s37, s29, 4
    v_add_u32 v5, s37, v5
    v_xor_b32 v9, 16, v5
    s_lshl_b32 s43, s43, 2
    s_mov_b32 s46, 0
    s_cmp_eq_u32 s27, 0
    s_cbranch_scc0 K1_EPI_Z1
K1_EN_19:
    ds_read_b64 v[112:113], v10
    s_set_gpr_idx_on s46, 0x1
    v_mov_b32 v176, v192
    v_mov_b32 v177, v193
    v_mov_b32 v178, v194
    v_mov_b32 v179, v195
    v_mov_b32 v180, v208
    v_mov_b32 v181, v209
    v_mov_b32 v182, v210
    v_mov_b32 v183, v211
    v_mov_b32 v184, v224
    v_mov_b32 v185, v225
    v_mov_b32 v186, v226
    v_mov_b32 v187, v227
    v_mov_b32 v188, v240
    v_mov_b32 v189, v241
    v_mov_b32 v190, v242
    v_mov_b32 v191, v243
    s_set_gpr_idx_off
    v_add_u32 v10, 32, v10
    s_waitcnt lgkmcnt(0)
    v_mul_f32 v160, v113, v144
    v_mul_f32 v161, v113, v145
    v_mul_f32 v162, v113, v146
    v_mul_f32 v163, v113, v147
    v_fma_f32 v176, v176, v112, -v160
    v_fma_f32 v177, v177, v112, -v161
    v_fma_f32 v178, v178, v112, -v162
    v_fma_f32 v179, v179, v112, -v163
    v_mul_f32 v160, s40, v176
    v_mul_f32 v161, s40, v177
    v_mul_f32 v162, s40, v178
    v_mul_f32 v163, s40, v179
    v_min_f32 v160, 0, v160
    v_min_f32 v161, 0, v161
    v_min_f32 v162, 0, v162
    v_min_f32 v163, 0, v163
    v_exp_f32 v160, v160
    v_exp_f32 v161, v161
    v_exp_f32 v162, v162
    v_exp_f32 v163, v163
    v_max_f32 v176, 0, v176
    v_max_f32 v177, 0, v177
    v_max_f32 v178, 0, v178
    v_max_f32 v179, 0, v179
    v_add_f32 v176, s41, v176
    v_add_f32 v177, s41, v177
    v_add_f32 v178, s41, v178
    v_add_f32 v179, s41, v179
    v_add_f32 v176, v176, v160
    v_add_f32 v177, v177, v161
    v_add_f32 v178, v178, v162
    v_add_f32 v179, v179, v163
    v_cvt_pk_bf16_f32 v36, v176, v177
    v_cvt_pk_bf16_f32 v37, v178, v179
    v_mul_f32 v164, v113, v148
    v_mul_f32 v165, v113, v149
    v_mul_f32 v166, v113, v150
    v_mul_f32 v167, v113, v151
    v_fma_f32 v180, v180, v112, -v164
    v_fma_f32 v181, v181, v112, -v165
    v_fma_f32 v182, v182, v112, -v166
    v_fma_f32 v183, v183, v112, -v167
    v_mul_f32 v164, s40, v180
    v_mul_f32 v165, s40, v181
    v_mul_f32 v166, s40, v182
    v_mul_f32 v167, s40, v183
    v_min_f32 v164, 0, v164
    v_min_f32 v165, 0, v165
    v_min_f32 v166, 0, v166
    v_min_f32 v167, 0, v167
    v_exp_f32 v164, v164
    v_exp_f32 v165, v165
    v_exp_f32 v166, v166
    v_exp_f32 v167, v167
    v_max_f32 v180, 0, v180
    v_max_f32 v181, 0, v181
    v_max_f32 v182, 0, v182
    v_max_f32 v183, 0, v183
    v_add_f32 v180, s41, v180
    v_add_f32 v181, s41, v181
    v_add_f32 v182, s41, v182
    v_add_f32 v183, s41, v183
    v_add_f32 v180, v180, v164
    v_add_f32 v181, v181, v165
    v_add_f32 v182, v182, v166
    v_add_f32 v183, v183, v167
    v_cvt_pk_bf16_f32 v38, v180, v181
    v_cvt_pk_bf16_f32 v39, v182, v183
    v_mul_f32 v168, v113, v152
    v_mul_f32 v169, v113, v153
    v_mul_f32 v170, v113, v154
    v_mul_f32 v171, v113, v155
    v_fma_f32 v184, v184, v112, -v168
    v_fma_f32 v185, v185, v112, -v169
    v_fma_f32 v186, v186, v112, -v170
    v_fma_f32 v187, v187, v112, -v171
    v_mul_f32 v168, s40, v184
    v_mul_f32 v169, s40, v185
    v_mul_f32 v170, s40, v186
    v_mul_f32 v171, s40, v187
    v_min_f32 v168, 0, v168
    v_min_f32 v169, 0, v169
    v_min_f32 v170, 0, v170
    v_min_f32 v171, 0, v171
    v_exp_f32 v168, v168
    v_exp_f32 v169, v169
    v_exp_f32 v170, v170
    v_exp_f32 v171, v171
    v_max_f32 v184, 0, v184
    v_max_f32 v185, 0, v185
    v_max_f32 v186, 0, v186
    v_max_f32 v187, 0, v187
    v_add_f32 v184, s41, v184
    v_add_f32 v185, s41, v185
    v_add_f32 v186, s41, v186
    v_add_f32 v187, s41, v187
    v_add_f32 v184, v184, v168
    v_add_f32 v185, v185, v169
    v_add_f32 v186, v186, v170
    v_add_f32 v187, v187, v171
    v_cvt_pk_bf16_f32 v40, v184, v185
    v_cvt_pk_bf16_f32 v41, v186, v187
    v_mul_f32 v172, v113, v156
    v_mul_f32 v173, v113, v157
    v_mul_f32 v174, v113, v158
    v_mul_f32 v175, v113, v159
    v_fma_f32 v188, v188, v112, -v172
    v_fma_f32 v189, v189, v112, -v173
    v_fma_f32 v190, v190, v112, -v174
    v_fma_f32 v191, v191, v112, -v175
    v_mul_f32 v172, s40, v188
    v_mul_f32 v173, s40, v189
    v_mul_f32 v174, s40, v190
    v_mul_f32 v175, s40, v191
    v_min_f32 v172, 0, v172
    v_min_f32 v173, 0, v173
    v_min_f32 v174, 0, v174
    v_min_f32 v175, 0, v175
    v_exp_f32 v172, v172
    v_exp_f32 v173, v173
    v_exp_f32 v174, v174
    v_exp_f32 v175, v175
    v_max_f32 v188, 0, v188
    v_max_f32 v189, 0, v189
    v_max_f32 v190, 0, v190
    v_max_f32 v191, 0, v191
    v_add_f32 v188, s41, v188
    v_add_f32 v189, s41, v189
    v_add_f32 v190, s41, v190
    v_add_f32 v191, s41, v191
    v_add_f32 v188, v188, v172
    v_add_f32 v189, v189, v173
    v_add_f32 v190, v190, v174
    v_add_f32 v191, v191, v175
    v_cvt_pk_bf16_f32 v42, v188, v189
    v_cvt_pk_bf16_f32 v43, v190, v191
    buffer_store_dwordx4 v[36:39], v5, s[20:23], s44 offen
    buffer_store_dwordx4 v[40:43], v9, s[20:23], s44 offen
    s_add_u32 s44, s44, s43
    s_add_u32 s46, s46, 4
    s_cmp_lt_u32 s46, 16
    s_cbranch_scc1 K1_EN_19
    s_endpgm
K1_EPI_Z1:
K1_EN_20:
    ds_read_b64 v[112:113], v10
    s_set_gpr_idx_on s46, 0x1
    v_mov_b32 v176, v192
    v_mov_b32 v177, v193
    v_mov_b32 v178, v194
    v_mov_b32 v179, v195
    v_mov_b32 v180, v208
    v_mov_b32 v181, v209
    v_mov_b32 v182, v210
    v_mov_b32 v183, v211
    v_mov_b32 v184, v224
    v_mov_b32 v185, v225
    v_mov_b32 v186, v226
    v_mov_b32 v187, v227
    v_mov_b32 v188, v240
    v_mov_b32 v189, v241
    v_mov_b32 v190, v242
    v_mov_b32 v191, v243
    s_set_gpr_idx_off
    v_add_u32 v10, 32, v10
    s_waitcnt lgkmcnt(0)
    v_mul_f32 v160, v113, v144
    v_mul_f32 v161, v113, v145
    v_mul_f32 v162, v113, v146
    v_mul_f32 v163, v113, v147
    v_fma_f32 v176, v176, v112, -v160
    v_fma_f32 v177, v177, v112, -v161
    v_fma_f32 v178, v178, v112, -v162
    v_fma_f32 v179, v179, v112, -v163
    v_mul_f32 v160, v176, v176
    v_mul_f32 v161, v177, v177
    v_mul_f32 v162, v178, v178
    v_mul_f32 v163, v179, v179
    v_fma_f32 v160, v160, s42, v4
    v_fma_f32 v161, v161, s42, v4
    v_fma_f32 v162, v162, s42, v4
    v_fma_f32 v163, v163, s42, v4
    v_mul_f32 v160, v160, v176
    v_mul_f32 v161, v161, v177
    v_mul_f32 v162, v162, v178
    v_mul_f32 v163, v163, v179
    v_exp_f32 v160, v160
    v_exp_f32 v161, v161
    v_exp_f32 v162, v162
    v_exp_f32 v163, v163
    v_add_f32 v160, 1.0, v160
    v_add_f32 v161, 1.0, v161
    v_add_f32 v162, 1.0, v162
    v_add_f32 v163, 1.0, v163
    v_rcp_f32 v160, v160
    v_rcp_f32 v161, v161
    v_rcp_f32 v162, v162
    v_rcp_f32 v163, v163
    v_mul_f32 v176, v176, v160
    v_mul_f32 v177, v177, v161
    v_mul_f32 v178, v178, v162
    v_mul_f32 v179, v179, v163
    v_cvt_pk_bf16_f32 v36, v176, v177
    v_cvt_pk_bf16_f32 v37, v178, v179
    v_mul_f32 v164, v113, v148
    v_mul_f32 v165, v113, v149
    v_mul_f32 v166, v113, v150
    v_mul_f32 v167, v113, v151
    v_fma_f32 v180, v180, v112, -v164
    v_fma_f32 v181, v181, v112, -v165
    v_fma_f32 v182, v182, v112, -v166
    v_fma_f32 v183, v183, v112, -v167
    v_mul_f32 v164, v180, v180
    v_mul_f32 v165, v181, v181
    v_mul_f32 v166, v182, v182
    v_mul_f32 v167, v183, v183
    v_fma_f32 v164, v164, s42, v4
    v_fma_f32 v165, v165, s42, v4
    v_fma_f32 v166, v166, s42, v4
    v_fma_f32 v167, v167, s42, v4
    v_mul_f32 v164, v164, v180
    v_mul_f32 v165, v165, v181
    v_mul_f32 v166, v166, v182
    v_mul_f32 v167, v167, v183
    v_exp_f32 v164, v164
    v_exp_f32 v165, v165
    v_exp_f32 v166, v166
    v_exp_f32 v167, v167
    v_add_f32 v164, 1.0, v164
    v_add_f32 v165, 1.0, v165
    v_add_f32 v166, 1.0, v166
    v_add_f32 v167, 1.0, v167
    v_rcp_f32 v164, v164
    v_rcp_f32 v165, v165
    v_rcp_f32 v166, v166
    v_rcp_f32 v167, v167
    v_mul_f32 v180, v180, v164
    v_mul_f32 v181, v181, v165
    v_mul_f32 v182, v182, v166
    v_mul_f32 v183, v183, v167
    v_cvt_pk_bf16_f32 v38, v180, v181
    v_cvt_pk_bf16_f32 v39, v182, v183
    v_mul_f32 v168, v113, v152
    v_mul_f32 v169, v113, v153
    v_mul_f32 v170, v113, v154
    v_mul_f32 v171, v113, v155
    v_fma_f32 v184, v184, v112, -v168
    v_fma_f32 v185, v185, v112, -v169
    v_fma_f32 v186, v186, v112, -v170
    v_fma_f32 v187, v187, v112, -v171
    v_mul_f32 v168, v184, v184
    v_mul_f32 v169, v185, v185
    v_mul_f32 v170, v186, v186
    v_mul_f32 v171, v187, v187
    v_fma_f32 v168, v168, s42, v4
    v_fma_f32 v169, v169, s42, v4
    v_fma_f32 v170, v170, s42, v4
    v_fma_f32 v171, v171, s42, v4
    v_mul_f32 v168, v168, v184
    v_mul_f32 v169, v169, v185
    v_mul_f32 v170, v170, v186
    v_mul_f32 v171, v171, v187
    v_exp_f32 v168, v168
    v_exp_f32 v169, v169
    v_exp_f32 v170, v170
    v_exp_f32 v171, v171
    v_add_f32 v168, 1.0, v168
    v_add_f32 v169, 1.0, v169
    v_add_f32 v170, 1.0, v170
    v_add_f32 v171, 1.0, v171
    v_rcp_f32 v168, v168
    v_rcp_f32 v169, v169
    v_rcp_f32 v170, v170
    v_rcp_f32 v171, v171
    v_mul_f32 v184, v184, v168
    v_mul_f32 v185, v185, v169
    v_mul_f32 v186, v186, v170
    v_mul_f32 v187, v187, v171
    v_cvt_pk_bf16_f32 v40, v184, v185
    v_cvt_pk_bf16_f32 v41, v186, v187
    v_mul_f32 v172, v113, v156
    v_mul_f32 v173, v113, v157
    v_mul_f32 v174, v113, v158
    v_mul_f32 v175, v113, v159
    v_fma_f32 v188, v188, v112, -v172
    v_fma_f32 v189, v189, v112, -v173
    v_fma_f32 v190, v190, v112, -v174
    v_fma_f32 v191, v191, v112, -v175
    v_mul_f32 v172, v188, v188
    v_mul_f32 v173, v189, v189
    v_mul_f32 v174, v190, v190
    v_mul_f32 v175, v191, v191
    v_fma_f32 v172, v172, s42, v4
    v_fma_f32 v173, v173, s42, v4
    v_fma_f32 v174, v174, s42, v4
    v_fma_f32 v175, v175, s42, v4
    v_mul_f32 v172, v172, v188
    v_mul_f32 v173, v173, v189
    v_mul_f32 v174, v174, v190
    v_mul_f32 v175, v175, v191
    v_exp_f32 v172, v172
    v_exp_f32 v173, v173
    v_exp_f32 v174, v174
    v_exp_f32 v175, v175
    v_add_f32 v172, 1.0, v172
    v_add_f32 v173, 1.0, v173
    v_add_f32 v174, 1.0, v174
    v_add_f32 v175, 1.0, v175
    v_rcp_f32 v172, v172
    v_rcp_f32 v173, v173
    v_rcp_f32 v174, v174
    v_rcp_f32 v175, v175
    v_mul_f32 v188, v188, v172
    v_mul_f32 v189, v189, v173
    v_mul_f32 v190, v190, v174
    v_mul_f32 v191, v191, v175
    v_cvt_pk_bf16_f32 v42, v188, v189
    v_cvt_pk_bf16_f32 v43, v190, v191
    buffer_store_dwordx4 v[36:39], v5, s[20:23], s44 offen
    buffer_store_dwordx4 v[40:43], v9, s[20:23], s44 offen
    s_add_u32 s44, s44, s43
    s_add_u32 s46, s46, 4
    s_cmp_lt_u32 s46, 16
    s_cbranch_scc1 K1_EN_20
    s_endpgm
K1_MAIN_T:
K1_LOOP_21:
    s_cmp_lt_u32 s49, 9
    s_cbranch_scc1 K1_NW_23
    s_waitcnt vmcnt(0)
K1_NW_23:
    s_waitcnt vmcnt(6) lgkmcnt(0)
    s_barrier
    v_add_u32 v16, s50, v11
    v_xor_b32 v17, 64, v16
    v_add_u32 v22, s52, v16
    v_xor_b32 v23, 64, v22
    v_add_u32 v18, s50, v12
    v_add_u32 v19, s50, v13
    v_add_u32 v20, s50, v14
    v_add_u32 v21, s50, v15
    s_cmp_lt_u32 s49, 8
    s_cbranch_scc0 K1_ND_22
    v_mfma_f32_16x16x32_bf16 v[192:195], v[56:59], v[88:91], v[192:195]
    ds_read_b128 v[40:43], v16 offset:0
    v_lshlrev_b32 v32, 16, v116
    v_and_b32 v33, s48, v116
    v_mfma_f32_16x16x32_bf16 v[196:199], v[60:63], v[88:91], v[196:199]
    ds_read_b128 v[44:47], v16 offset:512
    v_lshlrev_b32 v34, 16, v117
    v_and_b32 v35, s48, v117
    v_mfma_f32_16x16x32_bf16 v[200:203], v[64:67], v[88:91], v[200:203]
    ds_read_b128 v[48:51], v16 offset:1024
    v_lshlrev_b32 v36, 16, v118
    v_and_b32 v37, s48, v118
    v_mfma_f32_16x16x32_bf16 v[204:207], v[68:71], v[88:91], v[204:207]
    ds_read_b128 v[52:55], v16 offset:1536
    v_lshlrev_b32 v38, 16, v119
    v_and_b32 v39, s48, v119
    v_mfma_f32_16x16x32_bf16 v[208:211], v[56:59], v[92:95], v[208:211]
    ds_read_b64_tr_b16 v[72:73], v18 offset:0
    v_add_f32 v28, v28, v32
    v_fmac_f32 v30, v32, v32
    v_mfma_f32_16x16x32_bf16 v[212:215], v[60:63], v[92:95], v[212:215]
    ds_read_b64_tr_b16 v[74:75], v18 offset:512
    v_add_f32 v29, v29, v33
    v_fmac_f32 v31, v33, v33
    v_mfma_f32_16x16x32_bf16 v[216:219], v[64:67], v[92:95], v[216:219]
    ds_read_b64_tr_b16 v[76:77], v19 offset:0
    v_add_f32 v28, v28, v34
    v_fmac_f32 v30, v34, v34
    v_mfma_f32_16x16x32_bf16 v[220:223], v[68:71], v[92:95], v[220:223]
    ds_read_b64_tr_b16 v[78:79], v19 offset:512
    v_add_f32 v29, v29, v35
    v_fmac_f32 v31, v35, v35
    v_mfma_f32_16x16x32_bf16 v[224:227], v[56:59], v[96:99], v[224:227]
    ds_read_b64_tr_b16 v[80:81], v20 offset:0
    v_add_f32 v28, v28, v36
    v_fmac_f32 v30, v36, v36
    v_mfma_f32_16x16x32_bf16 v[228:231], v[60:63], v[96:99], v[228:231]
    ds_read_b64_tr_b16 v[82:83], v20 offset:512
    v_add_f32 v29, v29, v37
    v_fmac_f32 v31, v37, v37
    v_mfma_f32_16x16x32_bf16 v[232:235], v[64:67], v[96:99], v[232:235]
    ds_read_b64_tr_b16 v[84:85], v21 offset:0
    v_add_f32 v28, v28, v38
    v_fmac_f32 v30, v38, v38
    v_mfma_f32_16x16x32_bf16 v[236:239], v[68:71], v[96:99], v[236:239]
    ds_read_b64_tr_b16 v[86:87], v21 offset:512
    v_add_f32 v29, v29, v39
    v_fmac_f32 v31, v39, v39
    v_mfma_f32_16x16x32_bf16 v[240:243], v[56:59], v[100:103], v[240:243]
    ds_read_b128 v[112:115], v22
    s_add_u32 s46, s34, s51
    s_add_u32 m0, s46, 0
    s_add_u32 s45, s31, 0
    buffer_load_dwordx4 v8, s[12:15], s45 offen lds
    v_mfma_f32_16x16x32_bf16 v[244:247], v[60:63], v[100:103], v[244:247]
    s_add_u32 s46, s34, s51
    s_add_u32 m0, s46, 1024
    s_add_u32 s45, s31, 10240
    buffer_load_dwordx4 v8, s[12:15], s45 offen lds
    v_mfma_f32_16x16x32_bf16 v[248:251], v[64:67], v[100:103], v[248:251]
    s_add_u32 s46, s35, s51
    s_add_u32 m0, s46, 0
    s_mov_b32 s47, s32
    buffer_load_dwordx4 v9, s[16:19], s47 offen lds
    v_mfma_f32_16x16x32_bf16 v[252:255], v[68:71], v[100:103], v[252:255]
    s_add_u32 s46, s35, s51
    s_add_u32 m0, s46, 1024
    s_add_u32 s47, s47, s43
    buffer_load_dwordx4 v9, s[16:19], s47 offen lds
    v_mfma_f32_16x16x32_bf16 v[104:107], v[24:27], v[88:91], v[104:107]
    s_add_u32 s46, s35, s51
    s_add_u32 m0, s46, 2048
    s_add_u32 s47, s47, s43
    buffer_load_dwordx4 v9, s[16:19], s47 offen lds
    v_mfma_f32_16x16x32_bf16 v[108:111], v[24:27], v[92:95], v[108:111]
    s_add_u32 s46, s35, s51
    s_add_u32 m0, s46, 3072
    s_add_u32 s47, s47, s43
    buffer_load_dwordx4 v9, s[16:19], s47 offen lds
    s_add_u32 s32, s32, s44
    s_add_u32 s31, s31, 128
    s_branch K1_J2_24
K1_ND_22:
    v_mfma_f32_16x16x32_bf16 v[192:195], v[56:59], v[88:91], v[192:195]
    ds_read_b128 v[40:43], v16 offset:0
    v_lshlrev_b32 v32, 16, v116
    v_and_b32 v33, s48, v116
    v_mfma_f32_16x16x32_bf16 v[196:199], v[60:63], v[88:91], v[196:199]
    ds_read_b128 v[44:47], v16 offset:512
    v_lshlrev_b32 v34, 16, v117
    v_and_b32 v35, s48, v117
    v_mfma_f32_16x16x32_bf16 v[200:203], v[64:67], v[88:91], v[200:203]
    ds_read_b128 v[48:51], v16 offset:1024
    v_lshlrev_b32 v36, 16, v118
    v_and_b32 v37, s48, v118
    v_mfma_f32_16x16x32_bf16 v[204:207], v[68:71], v[88:91], v[204:207]
    ds_read_b128 v[52:55], v16 offset:1536
    v_lshlrev_b32 v38, 16, v119
    v_and_b32 v39, s48, v119
    v_mfma_f32_16x16x32_bf16 v[208:211], v[56:59], v[92:95], v[208:211]
    ds_read_b64_tr_b16 v[72:73], v18 offset:0
    v_add_f32 v28, v28, v32
    v_fmac_f32 v30, v32, v32
    v_mfma_f32_16x16x32_bf16 v[212:215], v[60:63], v[92:95], v[212:215]
    ds_read_b64_tr_b16 v[74:75], v18 offset:512
    v_add_f32 v29, v29, v33
    v_fmac_f32 v31, v33, v33
    v_mfma_f32_16x16x32_bf16 v[216:219], v[64:67], v[92:95], v[216:219]
    ds_read_b64_tr_b16 v[76:77], v19 offset:0
    v_add_f32 v28, v28, v34
    v_fmac_f32 v30, v34, v34
    v_mfma_f32_16x16x32_bf16 v[220:223], v[68:71], v[92:95], v[220:223]
    ds_read_b64_tr_b16 v[78:79], v19 offset:512
    v_add_f32 v29, v29, v35
    v_fmac_f32 v31, v35, v35
    v_mfma_f32_16x16x32_bf16 v[224:227], v[56:59], v[96:99], v[224:227]
    ds_read_b64_tr_b16 v[80:81], v20 offset:0
    v_add_f32 v28, v28, v36
    v_fmac_f32 v30, v36, v36
    v_mfma_f32_16x16x32_bf16 v[228:231], v[60:63], v[96:99], v[228:231]
    ds_read_b64_tr_b16 v[82:83], v20 offset:512
    v_add_f32 v29, v29, v37
    v_fmac_f32 v31, v37, v37
    v_mfma_f32_16x16x32_bf16 v[232:235], v[64:67], v[96:99], v[232:235]
    ds_read_b64_tr_b16 v[84:85], v21 offset:0
    v_add_f32 v28, v28, v38
    v_fmac_f32 v30, v38, v38
    v_mfma_f32_16x16x32_bf16 v[236:239], v[68:71], v[96:99], v[236:239]
    ds_read_b64_tr_b16 v[86:87], v21 offset:512
    v_add_f32 v29, v29, v39
    v_fmac_f32 v31, v39, v39
    v_mfma_f32_16x16x32_bf16 v[240:243], v[56:59], v[100:103], v[240:243]
    ds_read_b128 v[112:115], v22
    v_mfma_f32_16x16x32_bf16 v[244:247], v[60:63], v[100:103], v[244:247]
    v_mfma_f32_16x16x32_bf16 v[248:251], v[64:67], v[100:103], v[248:251]
    v_mfma_f32_16x16x32_bf16 v[252:255], v[68:71], v[100:103], v[252:255]
    v_mfma_f32_16x16x32_bf16 v[104:107], v[24:27], v[88:91], v[104:107]
    v_mfma_f32_16x16x32_bf16 v[108:111], v[24:27], v[92:95], v[108:111]
K1_J2_24:
    s_waitcnt lgkmcnt(0)
    v_mfma_f32_16x16x32_bf16 v[192:195], v[40:43], v[72:75], v[192:195]
    ds_read_b128 v[56:59], v17 offset:0
    v_lshlrev_b32 v32, 16, v112
    v_and_b32 v33, s48, v112
    v_mfma_f32_16x16x32_bf16 v[196:199], v[44:47], v[72:75], v[196:199]
    ds_read_b128 v[60:63], v17 offset:512
    v_lshlrev_b32 v34, 16, v113
    v_and_b32 v35, s48, v113
    v_mfma_f32_16x16x32_bf16 v[200:203], v[48:51], v[72:75], v[200:203]
    ds_read_b128 v[64:67], v17 offset:1024
    v_lshlrev_b32 v36, 16, v114
    v_and_b32 v37, s48, v114
    v_mfma_f32_16x16x32_bf16 v[204:207], v[52:55], v[72:75], v[204:207]
    ds_read_b128 v[68:71], v17 offset:1536
    v_lshlrev_b32 v38, 16, v115
    v_and_b32 v39, s48, v115
    v_mfma_f32_16x16x32_bf16 v[208:211], v[40:43], v[76:79], v[208:211]
    ds_read_b64_tr_b16 v[88:89], v18 offset:4096
    v_add_f32 v28, v28, v32
    v_fmac_f32 v30, v32, v32
    v_mfma_f32_16x16x32_bf16 v[212:215], v[44:47], v[76:79], v[212:215]
    ds_read_b64_tr_b16 v[90:91], v18 offset:4608
    v_add_f32 v29, v29, v33
    v_fmac_f32 v31, v33, v33
    v_mfma_f32_16x16x32_bf16 v[216:219], v[48:51], v[76:79], v[216:219]
    ds_read_b64_tr_b16 v[92:93], v19 offset:4096
    v_add_f32 v28, v28, v34
    v_fmac_f32 v30, v34, v34
    v_mfma_f32_16x16x32_bf16 v[220:223], v[52:55], v[76:79], v[220:223]
    ds_read_b64_tr_b16 v[94:95], v19 offset:4608
    v_add_f32 v29, v29, v35
    v_fmac_f32 v31, v35, v35
    v_mfma_f32_16x16x32_bf16 v[224:227], v[40:43], v[80:83], v[224:227]
    ds_read_b64_tr_b16 v[96:97], v20 offset:4096
    v_add_f32 v28, v28, v36
    v_fmac_f32 v30, v36, v36
    v_mfma_f32_16x16x32_bf16 v[228:231], v[44:47], v[80:83], v[228:231]
    ds_read_b64_tr_b16 v[98:99], v20 offset:4608
    v_add_f32 v29, v29, v37
    v_fmac_f32 v31, v37, v37
    v_mfma_f32_16x16x32_bf16 v[232:235], v[48:51], v[80:83], v[232:235]
    ds_read_b64_tr_b16 v[100:101], v21 offset:4096
    v_add_f32 v28, v28, v38
    v_fmac_f32 v30, v38, v38
    v_mfma_f32_16x16x32_bf16 v[236:239], v[52:55], v[80:83], v[236:239]
    ds_read_b64_tr_b16 v[102:103], v21 offset:4608
    v_add_f32 v29, v29, v39
    v_fmac_f32 v31, v39, v39
    v_mfma_f32_16x16x32_bf16 v[240:243], v[40:43], v[84:87], v[240:243]
    ds_read_b128 v[116:119], v23
    v_mfma_f32_16x16x32_bf16 v[244:247], v[44:47], v[84:87], v[244:247]
    v_mfma_f32_16x16x32_bf16 v[248:251], v[48:51], v[84:87], v[248:251]
    v_mfma_f32_16x16x32_bf16 v[252:255], v[52:55], v[84:87], v[252:255]
    v_mfma_f32_16x16x32_bf16 v[104:107], v[24:27], v[72:75], v[104:107]
    v_mfma_f32_16x16x32_bf16 v[108:111], v[24:27], v[76:79], v[108:111]
    s_mov_b32 s51, s50
    s_add_u32 s50, s50, 49152
    s_cmp_eq_u32 s50, 147456
    s_cselect_b32 s50, 0, s50
    s_add_u32 s49, s49, 1
    s_cmp_lt_u32 s49, 10
    s_cbranch_scc1 K1_LOOP_21
    s_waitcnt lgkmcnt(0)
    v_mfma_f32_16x16x32_bf16 v[192:195], v[56:59], v[88:91], v[192:195]
    v_lshlrev_b32 v32, 16, v116
    v_and_b32 v33, s48, v116
    v_mfma_f32_16x16x32_bf16 v[196:199], v[60:63], v[88:91], v[196:199]
    v_lshlrev_b32 v34, 16, v117
    v_and_b32 v35, s48, v117
    v_mfma_f32_16x16x32_bf16 v[200:203], v[64:67], v[88:91], v[200:203]
    v_lshlrev_b32 v36, 16, v118
    v_and_b32 v37, s48, v118
    v_mfma_f32_16x16x32_bf16 v[204:207], v[68:71], v[88:91], v[204:207]
    v_lshlrev_b32 v38, 16, v119
    v_and_b32 v39, s48, v119
    v_mfma_f32_16x16x32_bf16 v[208:211], v[56:59], v[92:95], v[208:211]
    v_add_f32 v28, v28, v32
    v_fmac_f32 v30, v32, v32
    v_mfma_f32_16x16x32_bf16 v[212:215], v[60:63], v[92:95], v[212:215]
    v_add_f32 v29, v29, v33
    v_fmac_f32 v31, v33, v33
    v_mfma_f32_16x16x32_bf16 v[216:219], v[64:67], v[92:95], v[216:219]
    v_add_f32 v28, v28, v34
    v_fmac_f32 v30, v34, v34
    v_mfma_f32_16x16x32_bf16 v[220:223], v[68:71], v[92:95], v[220:223]
    v_add_f32 v29, v29, v35
    v_fmac_f32 v31, v35, v35
    v_mfma_f32_16x16x32_bf16 v[224:227], v[56:59], v[96:99], v[224:227]
    v_add_f32 v28, v28, v36
    v_fmac_f32 v30, v36, v36
    v_mfma_f32_16x16x32_bf16 v[228:231], v[60:63], v[96:99], v[228:231]
    v_add_f32 v29, v29, v37
    v_fmac_f32 v31, v37, v37
    v_mfma_f32_16x16x32_bf16 v[232:235], v[64:67], v[96:99], v[232:235]
    v_add_f32 v28, v28, v38
    v_fmac_f32 v30, v38, v38
    v_mfma_f32_16x16x32_bf16 v[236:239], v[68:71], v[96:99], v[236:239]
    v_add_f32 v29, v29, v39
    v_fmac_f32 v31, v39, v39
    v_mfma_f32_16x16x32_bf16 v[240:243], v[56:59], v[100:103], v[240:243]
    v_mfma_f32_16x16x32_bf16 v[244:247], v[60:63], v[100:103], v[244:247]
    v_mfma_f32_16x16x32_bf16 v[248:251], v[64:67], v[100:103], v[248:251]
    v_mfma_f32_16x16x32_bf16 v[252:255], v[68:71], v[100:103], v[252:255]
    v_mfma_f32_16x16x32_bf16 v[104:107], v[24:27], v[88:91], v[104:107]
    v_mfma_f32_16x16x32_bf16 v[108:111], v[24:27], v[92:95], v[108:111]
    s_nop 7
    v_add_f32 v28, v28, v29
    v_add_f32 v29, v30, v31
    v_xor_b32 v4, 16, v1
    v_lshlrev_b32 v4, 2, v4
    v_xor_b32 v5, 32, v1
    v_lshlrev_b32 v5, 2, v5
    ds_bpermute_b32 v6, v4, v28
    ds_bpermute_b32 v7, v4, v29
    s_waitcnt lgkmcnt(0)
    v_add_f32 v28, v28, v6
    v_add_f32 v29, v29, v7
    ds_bpermute_b32 v6, v5, v28
    ds_bpermute_b32 v7, v5, v29
    s_waitcnt lgkmcnt(0)
    v_add_f32 v28, v28, v6
    v_add_f32 v29, v29, v7
    s_mov_b32 s36, 0x3acccccd
    s_mov_b32 s37, 0x3727c5ac
    v_mul_f32 v28, s36, v28
    v_mul_f32 v29, s36, v29
    v_fma_f32 v29, -v28, v28, v29
    v_max_f32 v29, 0, v29
    v_add_f32 v29, s37, v29
    v_rsq_f32 v30, v29
    s_nop 0
    v_mul_f32 v31, v28, v30
    v_lshrrev_b32 v4, 7, v11
    s_lshl_b32 s36, s30, 2
    v_add_u32 v4, s36, v4
    v_lshlrev_b32 v4, 3, v4
    v_add_u32 v4, 147456, v4
    ds_write_b64 v4, v[30:31]
    s_lshl_b32 s36, s30, 8
    s_lshl_b32 s37, s29, 5
    s_add_u32 s36, s36, s37
    s_add_u32 s36, s36, 148480
    v_lshrrev_b32 v4, 2, v2
    v_lshlrev_b32 v4, 6, v4
    v_and_b32 v5, 3, v2
    v_lshl_add_u32 v4, v5, 2, v4
    v_add_u32 v4, s36, v4
    ds_write_b32 v4, v104
    ds_write_b32 v4, v108 offset:16
    s_waitcnt lgkmcnt(0)
    s_barrier
    s_mov_b32 s40, 0x3fb8aa3b
    s_mov_b32 s41, 0x358637bd
    s_mov_b32 s42, 0xbdd2d3e8
    v_mov_b32 v4, 0xc0135761
    s_lshl_b32 s36, s29, 9
    s_add_u32 s36, s36, 147456
    v_lshlrev_b32 v6, 7, v3
    v_add_u32 v6, s36, v6
    ds_read_b128 v[112:115], v6 offset:0
    ds_read_b128 v[116:119], v6 offset:16
    ds_read_b128 v[120:123], v6 offset:32
    ds_read_b128 v[124:127], v6 offset:48
    ds_read_b128 v[128:131], v6 offset:64
    ds_read_b128 v[132:135], v6 offset:80
    ds_read_b128 v[136:139], v6 offset:96
    ds_read_b128 v[140:143], v6 offset:112
    v_lshrrev_b32 v7, 2, v2
    v_lshlrev_b32 v7, 4, v7
    v_and_or_b32 v7, v2, 3, v7
    s_lshl_b32 s36, s30, 8
    s_add_u32 s36, s36, 148480
    v_lshlrev_b32 v6, 2, v7
    v_add_u32 v6, s36, v6
    v_mov_b32 v12, v6
    s_mov_b32 s46, 0
    s_mov_b32 s47, 0
    s_lshl_b32 s57, s29, 1
    s_cmp_eq_u32 s27, 4
    s_cbranch_scc1 K1_EPI_Z2
    s_mul_i32 s43, s26, 9216
    v_mul_u32_u24 v5, 144, v7
    v_lshl_add_u32 v5, v3, 5, v5
    v_add_u32 v5, s43, v5
    s_cmp_eq_u32 s27, 1
    s_cbranch_scc0 K1_EPI_V
K1_EK_25:
    s_xor_b32 s56, s47, s57
    s_lshl_b32 s37, s56, 4
    v_add_u32 v13, s37, v12
    ds_read_b32 v144, v13
    s_set_gpr_idx_on s46, 0x1
    v_mov_b32 v176, v192
    v_mov_b32 v177, v193
    v_mov_b32 v178, v194
    v_mov_b32 v179, v195
    v_mov_b32 v180, v196
    v_mov_b32 v181, v197
    v_mov_b32 v182, v198
    v_mov_b32 v183, v199
    v_mov_b32 v184, v200
    v_mov_b32 v185, v201
    v_mov_b32 v186, v202
    v_mov_b32 v187, v203
    v_mov_b32 v188, v204
    v_mov_b32 v189, v205
    v_mov_b32 v190, v206
    v_mov_b32 v191, v207
    s_set_gpr_idx_off
    s_waitcnt lgkmcnt(0)
    v_mul_f32 v160, v113, v144
    v_mul_f32 v161, v115, v144
    v_mul_f32 v162, v117, v144
    v_mul_f32 v163, v119, v144
    v_fma_f32 v176, v176, v112, -v160
    v_fma_f32 v177, v177, v114, -v161
    v_fma_f32 v178, v178, v116, -v162
    v_fma_f32 v179, v179, v118, -v163
    v_mul_f32 v160, s40, v176
    v_mul_f32 v161, s40, v177
    v_mul_f32 v162, s40, v178
    v_mul_f32 v163, s40, v179
    v_min_f32 v160, 0, v160
    v_min_f32 v161, 0, v161
    v_min_f32 v162, 0, v162
    v_min_f32 v163, 0, v163
    v_exp_f32 v160, v160
    v_exp_f32 v161, v161
    v_exp_f32 v162, v162
    v_exp_f32 v163, v163
    v_max_f32 v176, 0, v176
    v_max_f32 v177, 0, v177
    v_max_f32 v178, 0, v178
    v_max_f32 v179, 0, v179
    v_add_f32 v176, s41, v176
    v_add_f32 v177, s41, v177
    v_add_f32 v178, s41, v178
    v_add_f32 v179, s41, v179
    v_add_f32 v176, v176, v160
    v_add_f32 v177, v177, v161
    v_add_f32 v178, v178, v162
    v_add_f32 v179, v179, v163
    v_mul_f32 v164, v121, v144
    v_mul_f32 v165, v123, v144
    v_mul_f32 v166, v125, v144
    v_mul_f32 v167, v127, v144
    v_fma_f32 v180, v180, v120, -v164
    v_fma_f32 v181, v181, v122, -v165
    v_fma_f32 v182, v182, v124, -v166
    v_fma_f32 v183, v183, v126, -v167
    v_mul_f32 v164, s40, v180
    v_mul_f32 v165, s40, v181
    v_mul_f32 v166, s40, v182
    v_mul_f32 v167, s40, v183
    v_min_f32 v164, 0, v164
    v_min_f32 v165, 0, v165
    v_min_f32 v166, 0, v166
    v_min_f32 v167, 0, v167
    v_exp_f32 v164, v164
    v_exp_f32 v165, v165
    v_exp_f32 v166, v166
    v_exp_f32 v167, v167
    v_max_f32 v180, 0, v180
    v_max_f32 v181, 0, v181
    v_max_f32 v182, 0, v182
    v_max_f32 v183, 0, v183
    v_add_f32 v180, s41, v180
    v_add_f32 v181, s41, v181
    v_add_f32 v182, s41, v182
    v_add_f32 v183, s41, v183
    v_add_f32 v180, v180, v164
    v_add_f32 v181, v181, v165
    v_add_f32 v182, v182, v166
    v_add_f32 v183, v183, v167
    v_mul_f32 v168, v129, v144
    v_mul_f32 v169, v131, v144
    v_mul_f32 v170, v133, v144
    v_mul_f32 v171, v135, v144
    v_fma_f32 v184, v184, v128, -v168
    v_fma_f32 v185, v185, v130, -v169
    v_fma_f32 v186, v186, v132, -v170
    v_fma_f32 v187, v187, v134, -v171
    v_mul_f32 v168, s40, v184
    v_mul_f32 v169, s40, v185
    v_mul_f32 v170, s40, v186
    v_mul_f32 v171, s40, v187
    v_min_f32 v168, 0, v168
    v_min_f32 v169, 0, v169
    v_min_f32 v170, 0, v170
    v_min_f32 v171, 0, v171
    v_exp_f32 v168, v168
    v_exp_f32 v169, v169
    v_exp_f32 v170, v170
    v_exp_f32 v171, v171
    v_max_f32 v184, 0, v184
    v_max_f32 v185, 0, v185
    v_max_f32 v186, 0, v186
    v_max_f32 v187, 0, v187
    v_add_f32 v184, s41, v184
    v_add_f32 v185, s41, v185
    v_add_f32 v186, s41, v186
    v_add_f32 v187, s41, v187
    v_add_f32 v184, v184, v168
    v_add_f32 v185, v185, v169
    v_add_f32 v186, v186, v170
    v_add_f32 v187, v187, v171
    v_mul_f32 v172, v137, v144
    v_mul_f32 v173, v139, v144
    v_mul_f32 v174, v141, v144
    v_mul_f32 v175, v143, v144
    v_fma_f32 v188, v188, v136, -v172
    v_fma_f32 v189, v189, v138, -v173
    v_fma_f32 v190, v190, v140, -v174
    v_fma_f32 v191, v191, v142, -v175
    v_mul_f32 v172, s40, v188
    v_mul_f32 v173, s40, v189
    v_mul_f32 v174, s40, v190
    v_mul_f32 v175, s40, v191
    v_min_f32 v172, 0, v172
    v_min_f32 v173, 0, v173
    v_min_f32 v174, 0, v174
    v_min_f32 v175, 0, v175
    v_exp_f32 v172, v172
    v_exp_f32 v173, v173
    v_exp_f32 v174, v174
    v_exp_f32 v175, v175
    v_max_f32 v188, 0, v188
    v_max_f32 v189, 0, v189
    v_max_f32 v190, 0, v190
    v_max_f32 v191, 0, v191
    v_add_f32 v188, s41, v188
    v_add_f32 v189, s41, v189
    v_add_f32 v190, s41, v190
    v_add_f32 v191, s41, v191
    v_add_f32 v188, v188, v172
    v_add_f32 v189, v189, v173
    v_add_f32 v190, v190, v174
    v_add_f32 v191, v191, v175
    v_cvt_pk_bf16_f32 v36, v176, v177
    v_cvt_pk_bf16_f32 v37, v178, v179
    v_cvt_pk_bf16_f32 v38, v180, v181
    v_cvt_pk_bf16_f32 v39, v182, v183
    v_cvt_pk_bf16_f32 v40, v184, v185
    v_cvt_pk_bf16_f32 v41, v186, v187
    v_cvt_pk_bf16_f32 v42, v188, v189
    v_cvt_pk_bf16_f32 v43, v190, v191
    s_mul_i32 s37, s56, 576
    v_add_u32 v8, s37, v5
    ds_write_b128 v8, v[36:39]
    ds_write_b128 v8, v[40:43] offset:16
    s_add_u32 s46, s46, 16
    s_add_u32 s47, s47, 1
    s_cmp_lt_u32 s47, 4
    s_cbranch_scc1 K1_EK_25
    s_branch K1_KVJOIN
K1_EPI_V:
K1_EK_26:
    s_xor_b32 s56, s47, s57
    s_lshl_b32 s37, s56, 4
    v_add_u32 v13, s37, v12
    ds_read_b32 v144, v13
    s_set_gpr_idx_on s46, 0x1
    v_mov_b32 v176, v192
    v_mov_b32 v177, v193
    v_mov_b32 v178, v194
    v_mov_b32 v179, v195
    v_mov_b32 v180, v196
    v_mov_b32 v181, v197
    v_mov_b32 v182, v198
    v_mov_b32 v183, v199
    v_mov_b32 v184, v200
    v_mov_b32 v185, v201
    v_mov_b32 v186, v202
    v_mov_b32 v187, v203
    v_mov_b32 v188, v204
    v_mov_b32 v189, v205
    v_mov_b32 v190, v206
    v_mov_b32 v191, v207
    s_set_gpr_idx_off
    s_waitcnt lgkmcnt(0)
    v_mul_f32 v160, v113, v144
    v_mul_f32 v161, v115, v144
    v_mul_f32 v162, v117, v144
    v_mul_f32 v163, v119, v144
    v_fma_f32 v176, v176, v112, -v160
    v_fma_f32 v177, v177, v114, -v161
    v_fma_f32 v178, v178, v116, -v162
    v_fma_f32 v179, v179, v118, -v163
    v_mul_f32 v164, v121, v144
    v_mul_f32 v165, v123, v144
    v_mul_f32 v166, v125, v144
    v_mul_f32 v167, v127, v144
    v_fma_f32 v180, v180, v120, -v164
    v_fma_f32 v181, v181, v122, -v165
    v_fma_f32 v182, v182, v124, -v166
    v_fma_f32 v183, v183, v126, -v167
    v_mul_f32 v168, v129, v144
    v_mul_f32 v169, v131, v144
    v_mul_f32 v170, v133, v144
    v_mul_f32 v171, v135, v144
    v_fma_f32 v184, v184, v128, -v168
    v_fma_f32 v185, v185, v130, -v169
    v_fma_f32 v186, v186, v132, -v170
    v_fma_f32 v187, v187, v134, -v171
    v_mul_f32 v172, v137, v144
    v_mul_f32 v173, v139, v144
    v_mul_f32 v174, v141, v144
    v_mul_f32 v175, v143, v144
    v_fma_f32 v188, v188, v136, -v172
    v_fma_f32 v189, v189, v138, -v173
    v_fma_f32 v190, v190, v140, -v174
    v_fma_f32 v191, v191, v142, -v175
    v_cvt_pk_bf16_f32 v36, v176, v177
    v_cvt_pk_bf16_f32 v37, v178, v179
    v_cvt_pk_bf16_f32 v38, v180, v181
    v_cvt_pk_bf16_f32 v39, v182, v183
    v_cvt_pk_bf16_f32 v40, v184, v185
    v_cvt_pk_bf16_f32 v41, v186, v187
    v_cvt_pk_bf16_f32 v42, v188, v189
    v_cvt_pk_bf16_f32 v43, v190, v191
    s_mul_i32 s37, s56, 576
    v_add_u32 v8, s37, v5
    ds_write_b128 v8, v[36:39]
    ds_write_b128 v8, v[40:43] offset:16
    s_add_u32 s46, s46, 16
    s_add_u32 s47, s47, 1
    s_cmp_lt_u32 s47, 4
    s_cbranch_scc1 K1_EK_26
K1_KVJOIN:
    s_waitcnt lgkmcnt(0)
    s_barrier
    s_cmp_ge_u32 s26, 6
    s_cbranch_scc1 K1_KVDONE
    s_lshr_b32 s57, s26, 1
    s_mul_i32 s44, s28, 3
    s_add_u32 s44, s44, s57
    s_cmp_ge_u32 s44, 32
    s_cbranch_scc1 K1_KVDONE
    s_and_b32 s43, s26, 1
    s_mul_i32 s43, s43, 9216
    s_mul_i32 s45, s57, 2880
    s_add_u32 s43, s43, s45
    v_mul_u32_u24 v5, 144, v2
    v_lshl_add_u32 v5, v3, 4, v5
    v_add_u32 v5, s43, v5
    ds_read_b128 v[40:43], v5 offset:0
    ds_read_b128 v[44:47], v5 offset:2304
    ds_read_b128 v[48:51], v5 offset:18432
    ds_read_b128 v[52:55], v5 offset:20736
    ds_read_b128 v[56:59], v5 offset:64
    ds_read_b128 v[60:63], v5 offset:2368
    ds_read_b128 v[64:67], v5 offset:18496
    ds_read_b128 v[68:71], v5 offset:20800
    ds_read_b128 v[72:75], v5 offset:36864
    ds_read_b128 v[76:79], v5 offset:39168
    ds_read_b128 v[80:83], v5 offset:55296
    ds_read_b128 v[84:87], v5 offset:57600
    ds_read_b128 v[88:91], v5 offset:36928
    ds_read_b128 v[92:95], v5 offset:39232
    ds_read_b128 v[96:99], v5 offset:55360
    ds_read_b128 v[100:103], v5 offset:57664
    v_mul_u32_u24 v6, 80, v2
    v_lshl_add_u32 v6, v3, 4, v6
    v_cmp_gt_u32 s[46:47], 4, v2
    v_cmp_eq_u32 s[48:49], 0, v3
    v_cmp_eq_u32 s[50:51], 0, v2
    s_and_b64 s[52:53], s[46:47], s[48:49]
    s_and_b64 s[54:55], s[50:51], s[48:49]
    s_lshl_b32 s45, s24, 5
    s_add_u32 s45, s45, s44
    s_mul_i32 s45, s45, 1680
    s_add_u32 s45, s45, 2621440
    s_waitcnt lgkmcnt(12)
    v_mfma_f32_16x16x32_bf16 v[112:115], v[40:43], v[48:51], 0
    v_mfma_f32_16x16x32_bf16 v[116:119], v[40:43], v[52:55], 0
    v_mfma_f32_16x16x32_bf16 v[120:123], v[44:47], v[48:51], 0
    v_mfma_f32_16x16x32_bf16 v[124:127], v[44:47], v[52:55], 0
    v_mfma_f32_16x16x32_bf16 v[128:131], v[40:43], v[24:27], 0
    v_mfma_f32_16x16x32_bf16 v[132:135], v[44:47], v[24:27], 0
    s_waitcnt lgkmcnt(8)
    v_mfma_f32_16x16x32_bf16 v[112:115], v[56:59], v[64:67], v[112:115]
    v_mfma_f32_16x16x32_bf16 v[116:119], v[56:59], v[68:71], v[116:119]
    v_mfma_f32_16x16x32_bf16 v[120:123], v[60:63], v[64:67], v[120:123]
    v_mfma_f32_16x16x32_bf16 v[124:127], v[60:63], v[68:71], v[124:127]
    v_mfma_f32_16x16x32_bf16 v[128:131], v[56:59], v[24:27], v[128:131]
    v_mfma_f32_16x16x32_bf16 v[132:135], v[60:63], v[24:27], v[132:135]
    s_waitcnt lgkmcnt(4)
    v_mfma_f32_16x16x32_bf16 v[112:115], v[72:75], v[80:83], v[112:115]
    v_mfma_f32_16x16x32_bf16 v[116:119], v[72:75], v[84:87], v[116:119]
    v_mfma_f32_16x16x32_bf16 v[120:123], v[76:79], v[80:83], v[120:123]
    v_mfma_f32_16x16x32_bf16 v[124:127], v[76:79], v[84:87], v[124:127]
    v_mfma_f32_16x16x32_bf16 v[128:131], v[72:75], v[24:27], v[128:131]
    v_mfma_f32_16x16x32_bf16 v[132:135], v[76:79], v[24:27], v[132:135]
    s_waitcnt lgkmcnt(0)
    v_mfma_f32_16x16x32_bf16 v[112:115], v[88:91], v[96:99], v[112:115]
    v_mfma_f32_16x16x32_bf16 v[116:119], v[88:91], v[100:103], v[116:119]
    v_mfma_f32_16x16x32_bf16 v[120:123], v[92:95], v[96:99], v[120:123]
    v_mfma_f32_16x16x32_bf16 v[124:127], v[92:95], v[100:103], v[124:127]
    v_mfma_f32_16x16x32_bf16 v[128:131], v[88:91], v[24:27], v[128:131]
    v_mfma_f32_16x16x32_bf16 v[132:135], v[92:95], v[24:27], v[132:135]
    s_nop 7
    buffer_store_dwordx4 v[112:115], v6, s[20:23], s45 offen offset:0
    s_mov_b64 exec, s[46:47]
    buffer_store_dwordx4 v[116:119], v6, s[20:23], s45 offen offset:1280
    s_mov_b64 exec, s[48:49]
    buffer_store_dwordx4 v[120:123], v6, s[20:23], s45 offen offset:64
    s_mov_b64 exec, s[52:53]
    buffer_store_dwordx4 v[124:127], v6, s[20:23], s45 offen offset:1344
    s_mov_b64 exec, s[50:51]
    buffer_store_dwordx4 v[128:131], v6, s[20:23], s45 offen offset:1600
    s_mov_b64 exec, s[54:55]
    buffer_store_dwordx4 v[132:135], v6, s[20:23], s45 offen offset:1664
    s_mov_b64 exec, -1
K1_KVDONE:
    s_endpgm
K1_EPI_Z2:
    s_lshl_b32 s44, s24, 2
    s_lshl_b32 s45, s29, 1
    s_add_u32 s44, s44, s45
    v_lshrrev_b32 v9, 1, v3
    v_add_u32 v9, s44, v9
    v_and_b32 v10, 1, v3
    v_lshlrev_b32 v10, 9, v10
    v_and_b32 v11, 3, v2
    v_lshl_add_u32 v10, v11, 4, v10
    s_lshl_b32 s44, s28, 4
    v_lshrrev_b32 v11, 2, v2
    v_lshlrev_b32 v11, 2, v11
    v_add_u32 v11, s44, v11
    s_mov_b32 s45, 11010048
    v_mov_b32 v56, 0
    v_mov_b32 v57, 0
    v_mov_b32 v58, 0
    v_mov_b32 v59, 0
    v_mov_b32 v60, 0
    v_mov_b32 v61, 0
    v_mov_b32 v62, 0
    v_mov_b32 v63, 0
    v_mov_b32 v64, 0
    v_mov_b32 v65, 0
    v_mov_b32 v66, 0
    v_mov_b32 v67, 0
    v_mov_b32 v68, 0
    v_mov_b32 v69, 0
    v_mov_b32 v70, 0
    v_mov_b32 v71, 0
    v_mov_b32 v72, 0
    v_mov_b32 v73, 0
    v_mov_b32 v74, 0
    v_mov_b32 v75, 0
    v_mov_b32 v76, 0
    v_mov_b32 v77, 0
    v_mov_b32 v78, 0
    v_mov_b32 v79, 0
    v_mov_b32 v80, 0
    v_mov_b32 v81, 0
    v_mov_b32 v82, 0
    v_mov_b32 v83, 0
    v_mov_b32 v84, 0
    v_mov_b32 v85, 0
    v_mov_b32 v86, 0
    v_mov_b32 v87, 0
K1_EZ_27:
    s_xor_b32 s56, s47, s57
    s_lshl_b32 s37, s56, 4
    v_add_u32 v13, s37, v12
    ds_read_b32 v144, v13
    s_set_gpr_idx_on s46, 0x1
    v_mov_b32 v176, v192
    v_mov_b32 v177, v193
    v_mov_b32 v178, v194
    v_mov_b32 v179, v195
    v_mov_b32 v180, v196
    v_mov_b32 v181, v197
    v_mov_b32 v182, v198
    v_mov_b32 v183, v199
    v_mov_b32 v184, v200
    v_mov_b32 v185, v201
    v_mov_b32 v186, v202
    v_mov_b32 v187, v203
    v_mov_b32 v188, v204
    v_mov_b32 v189, v205
    v_mov_b32 v190, v206
    v_mov_b32 v191, v207
    s_set_gpr_idx_off
    s_waitcnt lgkmcnt(0)
    v_mul_f32 v160, v113, v144
    v_mul_f32 v161, v115, v144
    v_mul_f32 v162, v117, v144
    v_mul_f32 v163, v119, v144
    v_fma_f32 v176, v176, v112, -v160
    v_fma_f32 v177, v177, v114, -v161
    v_fma_f32 v178, v178, v116, -v162
    v_fma_f32 v179, v179, v118, -v163
    v_mul_f32 v160, v176, v176
    v_mul_f32 v161, v177, v177
    v_mul_f32 v162, v178, v178
    v_mul_f32 v163, v179, v179
    v_fma_f32 v160, v160, s42, v4
    v_fma_f32 v161, v161, s42, v4
    v_fma_f32 v162, v162, s42, v4
    v_fma_f32 v163, v163, s42, v4
    v_mul_f32 v160, v160, v176
    v_mul_f32 v161, v161, v177
    v_mul_f32 v162, v162, v178
    v_mul_f32 v163, v163, v179
    v_exp_f32 v160, v160
    v_exp_f32 v161, v161
    v_exp_f32 v162, v162
    v_exp_f32 v163, v163
    v_add_f32 v160, 1.0, v160
    v_add_f32 v161, 1.0, v161
    v_add_f32 v162, 1.0, v162
    v_add_f32 v163, 1.0, v163
    v_rcp_f32 v160, v160
    v_rcp_f32 v161, v161
    v_rcp_f32 v162, v162
    v_rcp_f32 v163, v163
    v_mul_f32 v176, v176, v160
    v_mul_f32 v177, v177, v161
    v_mul_f32 v178, v178, v162
    v_mul_f32 v179, v179, v163
    v_mul_f32 v164, v121, v144
    v_mul_f32 v165, v123, v144
    v_mul_f32 v166, v125, v144
    v_mul_f32 v167, v127, v144
    v_fma_f32 v180, v180, v120, -v164
    v_fma_f32 v181, v181, v122, -v165
    v_fma_f32 v182, v182, v124, -v166
    v_fma_f32 v183, v183, v126, -v167
    v_mul_f32 v164, v180, v180
    v_mul_f32 v165, v181, v181
    v_mul_f32 v166, v182, v182
    v_mul_f32 v167, v183, v183
    v_fma_f32 v164, v164, s42, v4
    v_fma_f32 v165, v165, s42, v4
    v_fma_f32 v166, v166, s42, v4
    v_fma_f32 v167, v167, s42, v4
    v_mul_f32 v164, v164, v180
    v_mul_f32 v165, v165, v181
    v_mul_f32 v166, v166, v182
    v_mul_f32 v167, v167, v183
    v_exp_f32 v164, v164
    v_exp_f32 v165, v165
    v_exp_f32 v166, v166
    v_exp_f32 v167, v167
    v_add_f32 v164, 1.0, v164
    v_add_f32 v165, 1.0, v165
    v_add_f32 v166, 1.0, v166
    v_add_f32 v167, 1.0, v167
    v_rcp_f32 v164, v164
    v_rcp_f32 v165, v165
    v_rcp_f32 v166, v166
    v_rcp_f32 v167, v167
    v_mul_f32 v180, v180, v164
    v_mul_f32 v181, v181, v165
    v_mul_f32 v182, v182, v166
    v_mul_f32 v183, v183, v167
    v_mul_f32 v168, v129, v144
    v_mul_f32 v169, v131, v144
    v_mul_f32 v170, v133, v144
    v_mul_f32 v171, v135, v144
    v_fma_f32 v184, v184, v128, -v168
    v_fma_f32 v185, v185, v130, -v169
    v_fma_f32 v186, v186, v132, -v170
    v_fma_f32 v187, v187, v134, -v171
    v_mul_f32 v168, v184, v184
    v_mul_f32 v169, v185, v185
    v_mul_f32 v170, v186, v186
    v_mul_f32 v171, v187, v187
    v_fma_f32 v168, v168, s42, v4
    v_fma_f32 v169, v169, s42, v4
    v_fma_f32 v170, v170, s42, v4
    v_fma_f32 v171, v171, s42, v4
    v_mul_f32 v168, v168, v184
    v_mul_f32 v169, v169, v185
    v_mul_f32 v170, v170, v186
    v_mul_f32 v171, v171, v187
    v_exp_f32 v168, v168
    v_exp_f32 v169, v169
    v_exp_f32 v170, v170
    v_exp_f32 v171, v171
    v_add_f32 v168, 1.0, v168
    v_add_f32 v169, 1.0, v169
    v_add_f32 v170, 1.0, v170
    v_add_f32 v171, 1.0, v171
    v_rcp_f32 v168, v168
    v_rcp_f32 v169, v169
    v_rcp_f32 v170, v170
    v_rcp_f32 v171, v171
    v_mul_f32 v184, v184, v168
    v_mul_f32 v185, v185, v169
    v_mul_f32 v186, v186, v170
    v_mul_f32 v187, v187, v171
    v_mul_f32 v172, v137, v144
    v_mul_f32 v173, v139, v144
    v_mul_f32 v174, v141, v144
    v_mul_f32 v175, v143, v144
    v_fma_f32 v188, v188, v136, -v172
    v_fma_f32 v189, v189, v138, -v173
    v_fma_f32 v190, v190, v140, -v174
    v_fma_f32 v191, v191, v142, -v175
    v_mul_f32 v172, v188, v188
    v_mul_f32 v173, v189, v189
    v_mul_f32 v174, v190, v190
    v_mul_f32 v175, v191, v191
    v_fma_f32 v172, v172, s42, v4
    v_fma_f32 v173, v173, s42, v4
    v_fma_f32 v174, v174, s42, v4
    v_fma_f32 v175, v175, s42, v4
    v_mul_f32 v172, v172, v188
    v_mul_f32 v173, v173, v189
    v_mul_f32 v174, v174, v190
    v_mul_f32 v175, v175, v191
    v_exp_f32 v172, v172
    v_exp_f32 v173, v173
    v_exp_f32 v174, v174
    v_exp_f32 v175, v175
    v_add_f32 v172, 1.0, v172
    v_add_f32 v173, 1.0, v173
    v_add_f32 v174, 1.0, v174
    v_add_f32 v175, 1.0, v175
    v_rcp_f32 v172, v172
    v_rcp_f32 v173, v173
    v_rcp_f32 v174, v174
    v_rcp_f32 v175, v175
    v_mul_f32 v188, v188, v172
    v_mul_f32 v189, v189, v173
    v_mul_f32 v190, v190, v174
    v_mul_f32 v191, v191, v175
    v_add_u32 v5, s56, v11
    v_mul_u32_u24 v6, 2731, v5
    v_lshrrev_b32 v6, 16, v6
    v_mul_u32_u24 v7, 24, v6
    v_sub_u32 v5, v5, v7
    v_mul_u32_u24 v7, 43, v5
    v_lshrrev_b32 v7, 8, v7
    v_mul_u32_u24 v8, 6, v7
    v_sub_u32 v5, v5, v8
    v_lshl_add_u32 v6, v6, 6, v9
    v_mul_u32_u24 v6, 6, v6
    v_add_u32 v6, v6, v5
    v_lshl_add_u32 v6, v6, 10, v10
    v_lshl_add_u32 v6, v7, 6, v6
    v_cvt_pk_bf16_f32 v36, v176, v177
    v_cvt_pk_bf16_f32 v37, v178, v179
    v_cvt_pk_bf16_f32 v38, v180, v181
    v_cvt_pk_bf16_f32 v39, v182, v183
    v_cvt_pk_bf16_f32 v40, v184, v185
    v_cvt_pk_bf16_f32 v41, v186, v187
    v_cvt_pk_bf16_f32 v42, v188, v189
    v_cvt_pk_bf16_f32 v43, v190, v191
    buffer_store_dwordx4 v[36:39], v6, s[20:23], s45 offen
    buffer_store_dwordx4 v[40:43], v6, s[20:23], s45 offen offset:256
    v_add_f32 v56, v56, v176
    v_fmac_f32 v57, v176, v176
    v_add_f32 v58, v58, v177
    v_fmac_f32 v59, v177, v177
    v_add_f32 v60, v60, v178
    v_fmac_f32 v61, v178, v178
    v_add_f32 v62, v62, v179
    v_fmac_f32 v63, v179, v179
    v_add_f32 v64, v64, v180
    v_fmac_f32 v65, v180, v180
    v_add_f32 v66, v66, v181
    v_fmac_f32 v67, v181, v181
    v_add_f32 v68, v68, v182
    v_fmac_f32 v69, v182, v182
    v_add_f32 v70, v70, v183
    v_fmac_f32 v71, v183, v183
    v_add_f32 v72, v72, v184
    v_fmac_f32 v73, v184, v184
    v_add_f32 v74, v74, v185
    v_fmac_f32 v75, v185, v185
    v_add_f32 v76, v76, v186
    v_fmac_f32 v77, v186, v186
    v_add_f32 v78, v78, v187
    v_fmac_f32 v79, v187, v187
    v_add_f32 v80, v80, v188
    v_fmac_f32 v81, v188, v188
    v_add_f32 v82, v82, v189
    v_fmac_f32 v83, v189, v189
    v_add_f32 v84, v84, v190
    v_fmac_f32 v85, v190, v190
    v_add_f32 v86, v86, v191
    v_fmac_f32 v87, v191, v191
    s_add_u32 s46, s46, 16
    s_add_u32 s47, s47, 1
    s_cmp_lt_u32 s47, 4
    s_cbranch_scc1 K1_EZ_27
    v_add_f32_dpp v56, v56, v56 row_ror:8 row_mask:0xf bank_mask:0xf
    v_add_f32_dpp v57, v57, v57 row_ror:8 row_mask:0xf bank_mask:0xf
    v_add_f32_dpp v58, v58, v58 row_ror:8 row_mask:0xf bank_mask:0xf
    v_add_f32_dpp v59, v59, v59 row_ror:8 row_mask:0xf bank_mask:0xf
    v_add_f32_dpp v60, v60, v60 row_ror:8 row_mask:0xf bank_mask:0xf
    v_add_f32_dpp v61, v61, v61 row_ror:8 row_mask:0xf bank_mask:0xf
    v_add_f32_dpp v62, v62, v62 row_ror:8 row_mask:0xf bank_mask:0xf
    v_add_f32_dpp v63, v63, v63 row_ror:8 row_mask:0xf bank_mask:0xf
    v_add_f32_dpp v64, v64, v64 row_ror:8 row_mask:0xf bank_mask:0xf
    v_add_f32_dpp v65, v65, v65 row_ror:8 row_mask:0xf bank_mask:0xf
    v_add_f32_dpp v66, v66, v66 row_ror:8 row_mask:0xf bank_mask:0xf
    v_add_f32_dpp v67, v67, v67 row_ror:8 row_mask:0xf bank_mask:0xf
    v_add_f32_dpp v68, v68, v68 row_ror:8 row_mask:0xf bank_mask:0xf
    v_add_f32_dpp v69, v69, v69 row_ror:8 row_mask:0xf bank_mask:0xf
    v_add_f32_dpp v70, v70, v70 row_ror:8 row_mask:0xf bank_mask:0xf
    v_add_f32_dpp v71, v71, v71 row_ror:8 row_mask:0xf bank_mask:0xf
    v_add_f32_dpp v72, v72, v72 row_ror:8 row_mask:0xf bank_mask:0xf
    v_add_f32_dpp v73, v73, v73 row_ror:8 row_mask:0xf bank_mask:0xf
    v_add_f32_dpp v74, v74, v74 row_ror:8 row_mask:0xf bank_mask:0xf
    v_add_f32_dpp v75, v75, v75 row_ror:8 row_mask:0xf bank_mask:0xf
    v_add_f32_dpp v76, v76, v76 row_ror:8 row_mask:0xf bank_mask:0xf
    v_add_f32_dpp v77, v77, v77 row_ror:8 row_mask:0xf bank_mask:0xf
    v_add_f32_dpp v78, v78, v78 row_ror:8 row_mask:0xf bank_mask:0xf
    v_add_f32_dpp v79, v79, v79 row_ror:8 row_mask:0xf bank_mask:0xf
    v_add_f32_dpp v80, v80, v80 row_ror:8 row_mask:0xf bank_mask:0xf
    v_add_f32_dpp v81, v81, v81 row_ror:8 row_mask:0xf bank_mask:0xf
    v_add_f32_dpp v82, v82, v82 row_ror:8 row_mask:0xf bank_mask:0xf
    v_add_f32_dpp v83, v83, v83 row_ror:8 row_mask:0xf bank_mask:0xf
    v_add_f32_dpp v84, v84, v84 row_ror:8 row_mask:0xf bank_mask:0xf
    v_add_f32_dpp v85, v85, v85 row_ror:8 row_mask:0xf bank_mask:0xf
    v_add_f32_dpp v86, v86, v86 row_ror:8 row_mask:0xf bank_mask:0xf
    v_add_f32_dpp v87, v87, v87 row_ror:8 row_mask:0xf bank_mask:0xf
    v_add_f32_dpp v56, v56, v56 row_ror:4 row_mask:0xf bank_mask:0xf
    v_add_f32_dpp v57, v57, v57 row_ror:4 row_mask:0xf bank_mask:0xf
    v_add_f32_dpp v58, v58, v58 row_ror:4 row_mask:0xf bank_mask:0xf
    v_add_f32_dpp v59, v59, v59 row_ror:4 row_mask:0xf bank_mask:0xf
    v_add_f32_dpp v60, v60, v60 row_ror:4 row_mask:0xf bank_mask:0xf
    v_add_f32_dpp v61, v61, v61 row_ror:4 row_mask:0xf bank_mask:0xf
    v_add_f32_dpp v62, v62, v62 row_ror:4 row_mask:0xf bank_mask:0xf
    v_add_f32_dpp v63, v63, v63 row_ror:4 row_mask:0xf bank_mask:0xf
    v_add_f32_dpp v64, v64, v64 row_ror:4 row_mask:0xf bank_mask:0xf
    v_add_f32_dpp v65, v65, v65 row_ror:4 row_mask:0xf bank_mask:0xf
    v_add_f32_dpp v66, v66, v66 row_ror:4 row_mask:0xf bank_mask:0xf
    v_add_f32_dpp v67, v67, v67 row_ror:4 row_mask:0xf bank_mask:0xf
    v_add_f32_dpp v68, v68, v68 row_ror:4 row_mask:0xf bank_mask:0xf
    v_add_f32_dpp v69, v69, v69 row_ror:4 row_mask:0xf bank_mask:0xf
    v_add_f32_dpp v70, v70, v70 row_ror:4 row_mask:0xf bank_mask:0xf
    v_add_f32_dpp v71, v71, v71 row_ror:4 row_mask:0xf bank_mask:0xf
    v_add_f32_dpp v72, v72, v72 row_ror:4 row_mask:0xf bank_mask:0xf
    v_add_f32_dpp v73, v73, v73 row_ror:4 row_mask:0xf bank_mask:0xf
    v_add_f32_dpp v74, v74, v74 row_ror:4 row_mask:0xf bank_mask:0xf
    v_add_f32_dpp v75, v75, v75 row_ror:4 row_mask:0xf bank_mask:0xf
    v_add_f32_dpp v76, v76, v76 row_ror:4 row_mask:0xf bank_mask:0xf
    v_add_f32_dpp v77, v77, v77 row_ror:4 row_mask:0xf bank_mask:0xf
    v_add_f32_dpp v78, v78, v78 row_ror:4 row_mask:0xf bank_mask:0xf
    v_add_f32_dpp v79, v79, v79 row_ror:4 row_mask:0xf bank_mask:0xf
    v_add_f32_dpp v80, v80, v80 row_ror:4 row_mask:0xf bank_mask:0xf
    v_add_f32_dpp v81, v81, v81 row_ror:4 row_mask:0xf bank_mask:0xf
    v_add_f32_dpp v82, v82, v82 row_ror:4 row_mask:0xf bank_mask:0xf
    v_add_f32_dpp v83, v83, v83 row_ror:4 row_mask:0xf bank_mask:0xf
    v_add_f32_dpp v84, v84, v84 row_ror:4 row_mask:0xf bank_mask:0xf
    v_add_f32_dpp v85, v85, v85 row_ror:4 row_mask:0xf bank_mask:0xf
    v_add_f32_dpp v86, v86, v86 row_ror:4 row_mask:0xf bank_mask:0xf
    v_add_f32_dpp v87, v87, v87 row_ror:4 row_mask:0xf bank_mask:0xf
    v_add_f32_dpp v56, v56, v56 row_ror:2 row_mask:0xf bank_mask:0xf
    v_add_f32_dpp v57, v57, v57 row_ror:2 row_mask:0xf bank_mask:0xf
    v_add_f32_dpp v58, v58, v58 row_ror:2 row_mask:0xf bank_mask:0xf
    v_add_f32_dpp v59, v59, v59 row_ror:2 row_mask:0xf bank_mask:0xf
    v_add_f32_dpp v60, v60, v60 row_ror:2 row_mask:0xf bank_mask:0xf
    v_add_f32_dpp v61, v61, v61 row_ror:2 row_mask:0xf bank_mask:0xf
    v_add_f32_dpp v62, v62, v62 row_ror:2 row_mask:0xf bank_mask:0xf
    v_add_f32_dpp v63, v63, v63 row_ror:2 row_mask:0xf bank_mask:0xf
    v_add_f32_dpp v64, v64, v64 row_ror:2 row_mask:0xf bank_mask:0xf
    v_add_f32_dpp v65, v65, v65 row_ror:2 row_mask:0xf bank_mask:0xf
    v_add_f32_dpp v66, v66, v66 row_ror:2 row_mask:0xf bank_mask:0xf
    v_add_f32_dpp v67, v67, v67 row_ror:2 row_mask:0xf bank_mask:0xf
    v_add_f32_dpp v68, v68, v68 row_ror:2 row_mask:0xf bank_mask:0xf
    v_add_f32_dpp v69, v69, v69 row_ror:2 row_mask:0xf bank_mask:0xf
    v_add_f32_dpp v70, v70, v70 row_ror:2 row_mask:0xf bank_mask:0xf
    v_add_f32_dpp v71, v71, v71 row_ror:2 row_mask:0xf bank_mask:0xf
    v_add_f32_dpp v72, v72, v72 row_ror:2 row_mask:0xf bank_mask:0xf
    v_add_f32_dpp v73, v73, v73 row_ror:2 row_mask:0xf bank_mask:0xf
    v_add_f32_dpp v74, v74, v74 row_ror:2 row_mask:0xf bank_mask:0xf
    v_add_f32_dpp v75, v75, v75 row_ror:2 row_mask:0xf bank_mask:0xf
    v_add_f32_dpp v76, v76, v76 row_ror:2 row_mask:0xf bank_mask:0xf
    v_add_f32_dpp v77, v77, v77 row_ror:2 row_mask:0xf bank_mask:0xf
    v_add_f32_dpp v78, v78, v78 row_ror:2 row_mask:0xf bank_mask:0xf
    v_add_f32_dpp v79, v79, v79 row_ror:2 row_mask:0xf bank_mask:0xf
    v_add_f32_dpp v80, v80, v80 row_ror:2 row_mask:0xf bank_mask:0xf
    v_add_f32_dpp v81, v81, v81 row_ror:2 row_mask:0xf bank_mask:0xf
    v_add_f32_dpp v82, v82, v82 row_ror:2 row_mask:0xf bank_mask:0xf
    v_add_f32_dpp v83, v83, v83 row_ror:2 row_mask:0xf bank_mask:0xf
    v_add_f32_dpp v84, v84, v84 row_ror:2 row_mask:0xf bank_mask:0xf
    v_add_f32_dpp v85, v85, v85 row_ror:2 row_mask:0xf bank_mask:0xf
    v_add_f32_dpp v86, v86, v86 row_ror:2 row_mask:0xf bank_mask:0xf
    v_add_f32_dpp v87, v87, v87 row_ror:2 row_mask:0xf bank_mask:0xf
    v_add_f32_dpp v56, v56, v56 row_ror:1 row_mask:0xf bank_mask:0xf
    v_add_f32_dpp v57, v57, v57 row_ror:1 row_mask:0xf bank_mask:0xf
    v_add_f32_dpp v58, v58, v58 row_ror:1 row_mask:0xf bank_mask:0xf
    v_add_f32_dpp v59, v59, v59 row_ror:1 row_mask:0xf bank_mask:0xf
    v_add_f32_dpp v60, v60, v60 row_ror:1 row_mask:0xf bank_mask:0xf
    v_add_f32_dpp v61, v61, v61 row_ror:1 row_mask:0xf bank_mask:0xf
    v_add_f32_dpp v62, v62, v62 row_ror:1 row_mask:0xf bank_mask:0xf
    v_add_f32_dpp v63, v63, v63 row_ror:1 row_mask:0xf bank_mask:0xf
    v_add_f32_dpp v64, v64, v64 row_ror:1 row_mask:0xf bank_mask:0xf
    v_add_f32_dpp v65, v65, v65 row_ror:1 row_mask:0xf bank_mask:0xf
    v_add_f32_dpp v66, v66, v66 row_ror:1 row_mask:0xf bank_mask:0xf
    v_add_f32_dpp v67, v67, v67 row_ror:1 row_mask:0xf bank_mask:0xf
    v_add_f32_dpp v68, v68, v68 row_ror:1 row_mask:0xf bank_mask:0xf
    v_add_f32_dpp v69, v69, v69 row_ror:1 row_mask:0xf bank_mask:0xf
    v_add_f32_dpp v70, v70, v70 row_ror:1 row_mask:0xf bank_mask:0xf
    v_add_f32_dpp v71, v71, v71 row_ror:1 row_mask:0xf bank_mask:0xf
    v_add_f32_dpp v72, v72, v72 row_ror:1 row_mask:0xf bank_mask:0xf
    v_add_f32_dpp v73, v73, v73 row_ror:1 row_mask:0xf bank_mask:0xf
    v_add_f32_dpp v74, v74, v74 row_ror:1 row_mask:0xf bank_mask:0xf
    v_add_f32_dpp v75, v75, v75 row_ror:1 row_mask:0xf bank_mask:0xf
    v_add_f32_dpp v76, v76, v76 row_ror:1 row_mask:0xf bank_mask:0xf
    v_add_f32_dpp v77, v77, v77 row_ror:1 row_mask:0xf bank_mask:0xf
    v_add_f32_dpp v78, v78, v78 row_ror:1 row_mask:0xf bank_mask:0xf
    v_add_f32_dpp v79, v79, v79 row_ror:1 row_mask:0xf bank_mask:0xf
    v_add_f32_dpp v80, v80, v80 row_ror:1 row_mask:0xf bank_mask:0xf
    v_add_f32_dpp v81, v81, v81 row_ror:1 row_mask:0xf bank_mask:0xf
    v_add_f32_dpp v82, v82, v82 row_ror:1 row_mask:0xf bank_mask:0xf
    v_add_f32_dpp v83, v83, v83 row_ror:1 row_mask:0xf bank_mask:0xf
    v_add_f32_dpp v84, v84, v84 row_ror:1 row_mask:0xf bank_mask:0xf
    v_add_f32_dpp v85, v85, v85 row_ror:1 row_mask:0xf bank_mask:0xf
    v_add_f32_dpp v86, v86, v86 row_ror:1 row_mask:0xf bank_mask:0xf
    v_add_f32_dpp v87, v87, v87 row_ror:1 row_mask:0xf bank_mask:0xf
    s_lshl_b32 s36, s29, 9
    s_add_u32 s36, s36, 149504
    v_lshlrev_b32 v5, 7, v3
    v_add_u32 v5, s36, v5
    v_cmp_eq_u32 vcc, 0, v2
    s_and_saveexec_b64 s[46:47], vcc
    ds_add_f32 v5, v56 offset:0
    ds_add_f32 v5, v57 offset:4
    ds_add_f32 v5, v58 offset:8
    ds_add_f32 v5, v59 offset:12
    ds_add_f32 v5, v60 offset:16
    ds_add_f32 v5, v61 offset:20
    ds_add_f32 v5, v62 offset:24
    ds_add_f32 v5, v63 offset:28
    ds_add_f32 v5, v64 offset:32
    ds_add_f32 v5, v65 offset:36
    ds_add_f32 v5, v66 offset:40
    ds_add_f32 v5, v67 offset:44
    ds_add_f32 v5, v68 offset:48
    ds_add_f32 v5, v69 offset:52
    ds_add_f32 v5, v70 offset:56
    ds_add_f32 v5, v71 offset:60
    ds_add_f32 v5, v72 offset:64
    ds_add_f32 v5, v73 offset:68
    ds_add_f32 v5, v74 offset:72
    ds_add_f32 v5, v75 offset:76
    ds_add_f32 v5, v76 offset:80
    ds_add_f32 v5, v77 offset:84
    ds_add_f32 v5, v78 offset:88
    ds_add_f32 v5, v79 offset:92
    ds_add_f32 v5, v80 offset:96
    ds_add_f32 v5, v81 offset:100
    ds_add_f32 v5, v82 offset:104
    ds_add_f32 v5, v83 offset:108
    ds_add_f32 v5, v84 offset:112
    ds_add_f32 v5, v85 offset:116
    ds_add_f32 v5, v86 offset:120
    ds_add_f32 v5, v87 offset:124
    s_mov_b64 exec, s[46:47]
    s_waitcnt lgkmcnt(0)
    s_barrier
    s_cmp_lg_u32 s26, 0
    s_cbranch_scc1 K1_Z2DONE
    v_lshlrev_b32 v5, 4, v1
    v_add_u32 v6, 149504, v5
    ds_read_b128 v[8:11], v6
    s_lshr_b32 s43, s28, 2
    s_lshl_b32 s43, s43, 14
    s_add_u32 s43, s43, 14155776
    s_lshl_b32 s44, s24, 10
    s_add_u32 s43, s43, s44
    s_waitcnt lgkmcnt(0)
    buffer_store_dwordx4 v[8:11], v5, s[20:23], s43 offen
K1_Z2DONE:
    s_endpgm
K1_PF:
    s_load_dwordx2 s[4:5], s[0:1], 40
    s_load_dwordx2 s[6:7], s[0:1], 16
    s_load_dwordx2 s[8:9], s[0:1], 56
    s_load_dwordx2 s[28:29], s[0:1], 0
    s_load_dwordx2 s[30:31], s[0:1], 8
    s_load_dwordx2 s[32:33], s[0:1], 32
    s_sub_u32 s24, s2, 224
    s_and_b32 s25, s24, 7
    s_lshr_b32 s26, s24, 3
    s_lshl_b32 s27, s26, 9
    v_add_u32 v2, s27, v0
    v_lshlrev_b32 v2, 7, v2
    s_waitcnt lgkmcnt(0)
    s_mov_b32 s36, s28
    s_and_b32 s37, s29, 0xffff
    s_mov_b32 s38, 2621440
    s_mov_b32 s39, 0x00020000
    s_mov_b32 s40, s30
    s_and_b32 s41, s31, 0xffff
    s_mov_b32 s42, 2457600
    s_mov_b32 s43, 0x00020000
    s_mov_b32 s44, s32
    s_and_b32 s45, s33, 0xffff
    s_mov_b32 s46, 1966080
    s_mov_b32 s47, 0x00020000
    s_lshl_b32 s25, s25, 2
    s_add_u32 s25, s25, s26
    s_lshl_b32 s25, s25, 18
    v_lshlrev_b32 v1, 4, v0
    s_mov_b32 s12, s4
    s_and_b32 s13, s5, 0xffff
    s_mov_b32 s14, 8388608
    s_mov_b32 s15, 0x00020000
    s_mov_b32 s16, s6
    s_and_b32 s17, s7, 0xffff
    s_mov_b32 s18, 819200
    s_mov_b32 s19, 0x00020000
    s_mov_b32 s20, s8
    s_and_b32 s21, s9, 0xffff
    s_mov_b32 s22, 983040
    s_mov_b32 s23, 0x00020000
    buffer_load_dwordx4 v[8:11], v1, s[12:15], s25 offen
    s_add_u32 s25, s25, 8192
    buffer_load_dwordx4 v[12:15], v1, s[12:15], s25 offen
    s_add_u32 s25, s25, 8192
    s_waitcnt vmcnt(0)
    buffer_load_dwordx4 v[16:19], v1, s[12:15], s25 offen
    s_add_u32 s25, s25, 8192
    buffer_load_dwordx4 v[20:23], v1, s[12:15], s25 offen
    s_add_u32 s25, s25, 8192
    s_waitcnt vmcnt(0)
    buffer_load_dwordx4 v[24:27], v1, s[12:15], s25 offen
    s_add_u32 s25, s25, 8192
    buffer_load_dwordx4 v[28:31], v1, s[12:15], s25 offen
    s_add_u32 s25, s25, 8192
    s_waitcnt vmcnt(0)
    buffer_load_dwordx4 v[32:35], v1, s[12:15], s25 offen
    s_add_u32 s25, s25, 8192
    buffer_load_dwordx4 v[36:39], v1, s[12:15], s25 offen
    s_add_u32 s25, s25, 8192
    s_waitcnt vmcnt(0)
    buffer_load_dwordx4 v[40:43], v1, s[12:15], s25 offen
    s_add_u32 s25, s25, 8192
    buffer_load_dwordx4 v[44:47], v1, s[12:15], s25 offen
    s_add_u32 s25, s25, 8192
    s_waitcnt vmcnt(0)
    buffer_load_dwordx4 v[48:51], v1, s[12:15], s25 offen
    s_add_u32 s25, s25, 8192
    buffer_load_dwordx4 v[52:55], v1, s[12:15], s25 offen
    s_add_u32 s25, s25, 8192
    s_waitcnt vmcnt(0)
    buffer_load_dwordx4 v[56:59], v1, s[12:15], s25 offen
    s_add_u32 s25, s25, 8192
    buffer_load_dwordx4 v[60:63], v1, s[12:15], s25 offen
    s_add_u32 s25, s25, 8192
    s_waitcnt vmcnt(0)
    buffer_load_dwordx4 v[64:67], v1, s[12:15], s25 offen
    s_add_u32 s25, s25, 8192
    buffer_load_dwordx4 v[68:71], v1, s[12:15], s25 offen
    s_add_u32 s25, s25, 8192
    s_waitcnt vmcnt(0)
    buffer_load_dwordx4 v[8:11], v1, s[12:15], s25 offen
    s_add_u32 s25, s25, 8192
    buffer_load_dwordx4 v[12:15], v1, s[12:15], s25 offen
    s_add_u32 s25, s25, 8192
    s_waitcnt vmcnt(0)
    buffer_load_dwordx4 v[16:19], v1, s[12:15], s25 offen
    s_add_u32 s25, s25, 8192
    buffer_load_dwordx4 v[20:23], v1, s[12:15], s25 offen
    s_add_u32 s25, s25, 8192
    s_waitcnt vmcnt(0)
    buffer_load_dwordx4 v[24:27], v1, s[12:15], s25 offen
    s_add_u32 s25, s25, 8192
    buffer_load_dwordx4 v[28:31], v1, s[12:15], s25 offen
    s_add_u32 s25, s25, 8192
    s_waitcnt vmcnt(0)
    buffer_load_dwordx4 v[32:35], v1, s[12:15], s25 offen
    s_add_u32 s25, s25, 8192
    buffer_load_dwordx4 v[36:39], v1, s[12:15], s25 offen
    s_add_u32 s25, s25, 8192
    s_waitcnt vmcnt(0)
    buffer_load_dwordx4 v[40:43], v1, s[12:15], s25 offen
    s_add_u32 s25, s25, 8192
    buffer_load_dwordx4 v[44:47], v1, s[12:15], s25 offen
    s_add_u32 s25, s25, 8192
    s_waitcnt vmcnt(0)
    buffer_load_dwordx4 v[48:51], v1, s[12:15], s25 offen
    s_add_u32 s25, s25, 8192
    buffer_load_dwordx4 v[52:55], v1, s[12:15], s25 offen
    s_add_u32 s25, s25, 8192
    s_waitcnt vmcnt(0)
    buffer_load_dwordx4 v[56:59], v1, s[12:15], s25 offen
    s_add_u32 s25, s25, 8192
    buffer_load_dwordx4 v[60:63], v1, s[12:15], s25 offen
    s_add_u32 s25, s25, 8192
    s_waitcnt vmcnt(0)
    buffer_load_dwordx4 v[64:67], v1, s[12:15], s25 offen
    s_add_u32 s25, s25, 8192
    buffer_load_dwordx4 v[68:71], v1, s[12:15], s25 offen
    s_add_u32 s25, s25, 8192
    s_waitcnt vmcnt(0)
    s_mul_i32 s25, s24, 25600
    buffer_load_dwordx4 v[72:75], v1, s[16:19], s25 offen
    s_add_u32 s25, s25, 8192
    buffer_load_dwordx4 v[76:79], v1, s[16:19], s25 offen
    s_add_u32 s25, s25, 8192
    buffer_load_dwordx4 v[80:83], v1, s[16:19], s25 offen
    s_add_u32 s25, s25, 8192
    buffer_load_dwordx4 v[84:87], v1, s[16:19], s25 offen
    s_add_u32 s25, s25, 8192
    s_mul_i32 s25, s24, 30720
    buffer_load_dwordx4 v[88:91], v1, s[20:23], s25 offen
    s_add_u32 s25, s25, 8192
    buffer_load_dwordx4 v[92:95], v1, s[20:23], s25 offen
    s_add_u32 s25, s25, 8192
    buffer_load_dwordx4 v[96:99], v1, s[20:23], s25 offen
    s_add_u32 s25, s25, 8192
    buffer_load_dwordx4 v[100:103], v1, s[20:23], s25 offen
    s_add_u32 s25, s25, 8192
    s_waitcnt vmcnt(0)
K1_END:
    s_endpgm
.section .rodata,"a"
.p2align 6
.amdhsa_kernel k1_kernel
  .amdhsa_next_free_vgpr 256
  .amdhsa_next_free_sgpr 102
  .amdhsa_accum_offset 256
  .amdhsa_group_segment_fixed_size 0
  .amdhsa_kernarg_size 88
  .amdhsa_user_sgpr_count 2
  .amdhsa_user_sgpr_kernarg_segment_ptr 1
  .amdhsa_system_sgpr_workgroup_id_x 1
.end_amdhsa_kernel
.text
.globl k2_kernel
.p2align 8
.type k2_kernel,@function
k2_kernel:
    s_cmp_ge_u32 s2, 256
    s_cbranch_scc1 K2_END
    s_load_dwordx2 s[4:5], s[0:1], 40
    s_load_dwordx2 s[6:7], s[0:1], 48
    s_load_dwordx2 s[8:9], s[0:1], 16
    s_load_dwordx2 s[10:11], s[0:1], 80
    s_load_dwordx2 s[40:41], s[0:1], 56
    v_lshrrev_b32 v6, 6, v0
    v_and_b32 v1, 63, v0
    v_and_b32 v2, 15, v0
    v_readfirstlane_b32 s26, v6
    v_lshrrev_b32 v3, 4, v1
    s_waitcnt lgkmcnt(0)
    s_mov_b32 s20, s10
    s_and_b32 s21, s11, 0xffff
    s_mov_b32 s22, 21987328
    s_mov_b32 s23, 0x00020000
    s_cmp_ge_u32 s26, 4
    s_cbranch_scc1 K2_HELP
    s_mov_b32 s12, s4
    s_and_b32 s13, s5, 0xffff
    s_mov_b32 s14, 8388608
    s_mov_b32 s15, 0x00020000
    s_mov_b32 s16, s6
    s_and_b32 s17, s7, 0xffff
    s_mov_b32 s18, 4096
    s_mov_b32 s19, 0x00020000
    s_and_b32 s27, s2, 7
    s_lshl_b32 s27, s27, 2
    s_bfe_u32 s28, s2, 0x20003
    s_add_u32 s24, s27, s28
    s_lshr_b32 s25, s2, 5
    v_lshlrev_b32 v4, 4, v1
    v_add_u32 v5, 4096, v4
    s_lshl_b32 s32, s25, 6
    s_lshl_b32 s33, s26, 4
    s_add_u32 s32, s32, s33
    s_mul_i32 s27, s32, 6144
    s_add_u32 s27, s27, 11010048
    v_lshrrev_b32 v28, 3, v1
    v_and_b32 v29, 7, v1
    v_lshrrev_b32 v30, 1, v28
    v_xor_b32 v31, v29, v30
    v_lshlrev_b32 v28, 12, v28
    v_lshl_add_u32 v24, v31, 4, v28
    v_xor_b32 v25, 64, v24
    s_lshl_b32 s32, s24, 18
    s_lshl_b32 s33, s26, 10
    s_add_u32 s28, s32, s33
    s_lshl_b32 s29, s26, 15
    v_lshrrev_b32 v28, 1, v2
    v_xor_b32 v28, v28, v3
    v_lshlrev_b32 v29, 7, v2
    v_lshl_add_u32 v28, v28, 4, v29
    v_add_u32 v26, s29, v28
    v_xor_b32 v27, 64, v26
    v_lshlrev_b32 v28, 6, v1
    s_lshl_b32 s32, s26, 12
    s_add_u32 s32, s32, 14155776
    buffer_load_dwordx4 v[160:163], v28, s[20:23], s32 offen offset:0
    buffer_load_dwordx4 v[164:167], v28, s[20:23], s32 offen offset:16
    buffer_load_dwordx4 v[168:171], v28, s[20:23], s32 offen offset:32
    buffer_load_dwordx4 v[172:175], v28, s[20:23], s32 offen offset:48
    s_add_u32 s32, s32, 16384
    buffer_load_dwordx4 v[176:179], v28, s[20:23], s32 offen offset:0
    buffer_load_dwordx4 v[180:183], v28, s[20:23], s32 offen offset:16
    buffer_load_dwordx4 v[184:187], v28, s[20:23], s32 offen offset:32
    buffer_load_dwordx4 v[188:191], v28, s[20:23], s32 offen offset:48
    s_add_u32 s32, s32, 16384
    buffer_load_dwordx4 v[192:195], v28, s[20:23], s32 offen offset:0
    buffer_load_dwordx4 v[196:199], v28, s[20:23], s32 offen offset:16
    buffer_load_dwordx4 v[200:203], v28, s[20:23], s32 offen offset:32
    buffer_load_dwordx4 v[204:207], v28, s[20:23], s32 offen offset:48
    s_add_u32 s32, s32, 16384
    s_add_u32 m0, s29, 0
    s_add_u32 s34, s28, 0
    buffer_load_dwordx4 v24, s[12:15], s34 offen lds
    s_add_u32 m0, s29, 1024
    s_add_u32 s34, s28, 32768
    buffer_load_dwordx4 v25, s[12:15], s34 offen lds
    s_add_u32 m0, s29, 2048
    s_add_u32 s34, s28, 65536
    buffer_load_dwordx4 v24, s[12:15], s34 offen lds
    s_add_u32 m0, s29, 3072
    s_add_u32 s34, s28, 98304
    buffer_load_dwordx4 v25, s[12:15], s34 offen lds
    s_add_u32 m0, s29, 4096
    s_add_u32 s34, s28, 131072
    buffer_load_dwordx4 v24, s[12:15], s34 offen lds
    s_add_u32 m0, s29, 5120
    s_add_u32 s34, s28, 163840
    buffer_load_dwordx4 v25, s[12:15], s34 offen lds
    s_add_u32 m0, s29, 6144
    s_add_u32 s34, s28, 196608
    buffer_load_dwordx4 v24, s[12:15], s34 offen lds
    s_add_u32 m0, s29, 7168
    s_add_u32 s34, s28, 229376
    buffer_load_dwordx4 v25, s[12:15], s34 offen lds
    buffer_load_dwordx4 v[72:75], v4, s[20:23], s27 offen offset:0
    buffer_load_dwordx4 v[76:79], v4, s[20:23], s27 offen offset:1024
    buffer_load_dwordx4 v[80:83], v4, s[20:23], s27 offen offset:2048
    buffer_load_dwordx4 v[84:87], v4, s[20:23], s27 offen offset:3072
    buffer_load_dwordx4 v[88:91], v5, s[20:23], s27 offen offset:0
    buffer_load_dwordx4 v[92:95], v5, s[20:23], s27 offen offset:1024
    s_add_u32 s27, s27, 6144
    buffer_load_dwordx4 v[96:99], v4, s[20:23], s27 offen offset:0
    buffer_load_dwordx4 v[100:103], v4, s[20:23], s27 offen offset:1024
    buffer_load_dwordx4 v[104:107], v4, s[20:23], s27 offen offset:2048
    buffer_load_dwordx4 v[108:111], v4, s[20:23], s27 offen offset:3072
    buffer_load_dwordx4 v[112:115], v5, s[20:23], s27 offen offset:0
    buffer_load_dwordx4 v[116:119], v5, s[20:23], s27 offen offset:1024
    s_add_u32 s27, s27, 6144
    s_add_u32 m0, s29, 8192
    s_add_u32 s34, s28, 128
    buffer_load_dwordx4 v24, s[12:15], s34 offen lds
    s_add_u32 m0, s29, 9216
    s_add_u32 s34, s28, 32896
    buffer_load_dwordx4 v25, s[12:15], s34 offen lds
    s_add_u32 m0, s29, 10240
    s_add_u32 s34, s28, 65664
    buffer_load_dwordx4 v24, s[12:15], s34 offen lds
    s_add_u32 m0, s29, 11264
    s_add_u32 s34, s28, 98432
    buffer_load_dwordx4 v25, s[12:15], s34 offen lds
    s_add_u32 m0, s29, 12288
    s_add_u32 s34, s28, 131200
    buffer_load_dwordx4 v24, s[12:15], s34 offen lds
    s_add_u32 m0, s29, 13312
    s_add_u32 s34, s28, 163968
    buffer_load_dwordx4 v25, s[12:15], s34 offen lds
    s_add_u32 m0, s29, 14336
    s_add_u32 s34, s28, 196736
    buffer_load_dwordx4 v24, s[12:15], s34 offen lds
    s_add_u32 m0, s29, 15360
    s_add_u32 s34, s28, 229504
    buffer_load_dwordx4 v25, s[12:15], s34 offen lds
    buffer_load_dwordx4 v[120:123], v4, s[20:23], s27 offen offset:0
    buffer_load_dwordx4 v[124:127], v4, s[20:23], s27 offen offset:1024
    buffer_load_dwordx4 v[128:131], v4, s[20:23], s27 offen offset:2048
    buffer_load_dwordx4 v[132:135], v4, s[20:23], s27 offen offset:3072
    buffer_load_dwordx4 v[136:139], v5, s[20:23], s27 offen offset:0
    buffer_load_dwordx4 v[140:143], v5, s[20:23], s27 offen offset:1024
    s_add_u32 s27, s27, 6144
    s_add_u32 m0, s29, 16384
    s_add_u32 s34, s28, 256
    buffer_load_dwordx4 v24, s[12:15], s34 offen lds
    s_add_u32 m0, s29, 17408
    s_add_u32 s34, s28, 33024
    buffer_load_dwordx4 v25, s[12:15], s34 offen lds
    s_add_u32 m0, s29, 18432
    s_add_u32 s34, s28, 65792
    buffer_load_dwordx4 v24, s[12:15], s34 offen lds
    s_add_u32 m0, s29, 19456
    s_add_u32 s34, s28, 98560
    buffer_load_dwordx4 v25, s[12:15], s34 offen lds
    s_add_u32 m0, s29, 20480
    s_add_u32 s34, s28, 131328
    buffer_load_dwordx4 v24, s[12:15], s34 offen lds
    s_add_u32 m0, s29, 21504
    s_add_u32 s34, s28, 164096
    buffer_load_dwordx4 v25, s[12:15], s34 offen lds
    s_add_u32 m0, s29, 22528
    s_add_u32 s34, s28, 196864
    buffer_load_dwordx4 v24, s[12:15], s34 offen lds
    s_add_u32 m0, s29, 23552
    s_add_u32 s34, s28, 229632
    buffer_load_dwordx4 v25, s[12:15], s34 offen lds
    s_waitcnt vmcnt(42)
    v_add_f32 v144, v160, v176
    v_add_f32 v145, v161, v177
    v_add_f32 v146, v162, v178
    v_add_f32 v147, v163, v179
    v_add_f32 v148, v164, v180
    v_add_f32 v149, v165, v181
    v_add_f32 v150, v166, v182
    v_add_f32 v151, v167, v183
    v_add_f32 v152, v168, v184
    v_add_f32 v153, v169, v185
    v_add_f32 v154, v170, v186
    v_add_f32 v155, v171, v187
    v_add_f32 v156, v172, v188
    v_add_f32 v157, v173, v189
    v_add_f32 v158, v174, v190
    v_add_f32 v159, v175, v191
    v_add_f32 v144, v144, v192
    v_add_f32 v145, v145, v193
    v_add_f32 v146, v146, v194
    v_add_f32 v147, v147, v195
    v_add_f32 v148, v148, v196
    v_add_f32 v149, v149, v197
    v_add_f32 v150, v150, v198
    v_add_f32 v151, v151, v199
    v_add_f32 v152, v152, v200
    v_add_f32 v153, v153, v201
    v_add_f32 v154, v154, v202
    v_add_f32 v155, v155, v203
    v_add_f32 v156, v156, v204
    v_add_f32 v157, v157, v205
    v_add_f32 v158, v158, v206
    v_add_f32 v159, v159, v207
    s_mov_b32 s33, 0x3aaaaaab
    s_mov_b32 s34, 0x3727c5ac
    s_mov_b32 s35, 0xffff0000
    v_mul_f32 v160, s33, v144
    v_mul_f32 v168, s33, v145
    v_mul_f32 v161, s33, v146
    v_mul_f32 v169, s33, v147
    v_mul_f32 v162, s33, v148
    v_mul_f32 v170, s33, v149
    v_mul_f32 v163, s33, v150
    v_mul_f32 v171, s33, v151
    v_mul_f32 v164, s33, v152
    v_mul_f32 v172, s33, v153
    v_mul_f32 v165, s33, v154
    v_mul_f32 v173, s33, v155
    v_mul_f32 v166, s33, v156
    v_mul_f32 v174, s33, v157
    v_mul_f32 v167, s33, v158
    v_mul_f32 v175, s33, v159
    v_fma_f32 v168, -v160, v160, v168
    v_fma_f32 v169, -v161, v161, v169
    v_fma_f32 v170, -v162, v162, v170
    v_fma_f32 v171, -v163, v163, v171
    v_fma_f32 v172, -v164, v164, v172
    v_fma_f32 v173, -v165, v165, v173
    v_fma_f32 v174, -v166, v166, v174
    v_fma_f32 v175, -v167, v167, v175
    v_max_f32 v168, 0, v168
    v_max_f32 v169, 0, v169
    v_max_f32 v170, 0, v170
    v_max_f32 v171, 0, v171
    v_max_f32 v172, 0, v172
    v_max_f32 v173, 0, v173
    v_max_f32 v174, 0, v174
    v_max_f32 v175, 0, v175
    v_add_f32 v168, s34, v168
    v_add_f32 v169, s34, v169
    v_add_f32 v170, s34, v170
    v_add_f32 v171, s34, v171
    v_add_f32 v172, s34, v172
    v_add_f32 v173, s34, v173
    v_add_f32 v174, s34, v174
    v_add_f32 v175, s34, v175
    v_rsq_f32 v168, v168
    v_rsq_f32 v169, v169
    v_rsq_f32 v170, v170
    v_rsq_f32 v171, v171
    v_rsq_f32 v172, v172
    v_rsq_f32 v173, v173
    v_rsq_f32 v174, v174
    v_rsq_f32 v175, v175
    v_cvt_pk_bf16_f32 v176, v160, v161
    v_cvt_pk_bf16_f32 v177, v162, v163
    v_cvt_pk_bf16_f32 v178, v164, v165
    v_cvt_pk_bf16_f32 v179, v166, v167
    v_lshlrev_b32 v184, 16, v176
    v_and_b32 v185, s35, v176
    v_lshlrev_b32 v186, 16, v177
    v_and_b32 v187, s35, v177
    v_lshlrev_b32 v188, 16, v178
    v_and_b32 v189, s35, v178
    v_lshlrev_b32 v190, 16, v179
    v_and_b32 v191, s35, v179
    v_sub_f32 v184, v160, v184
    v_sub_f32 v185, v161, v185
    v_sub_f32 v186, v162, v186
    v_sub_f32 v187, v163, v187
    v_sub_f32 v188, v164, v188
    v_sub_f32 v189, v165, v189
    v_sub_f32 v190, v166, v190
    v_sub_f32 v191, v167, v191
    v_cvt_pk_bf16_f32 v180, v184, v185
    v_cvt_pk_bf16_f32 v181, v186, v187
    v_cvt_pk_bf16_f32 v182, v188, v189
    v_cvt_pk_bf16_f32 v183, v190, v191
    s_lshl_b32 s36, s26, 12
    s_add_u32 s36, s36, 131072
    v_lshlrev_b32 v28, 5, v1
    v_add_u32 v28, s36, v28
    v_lshlrev_b32 v29, 4, v1
    v_add_u32 v29, s36, v29
    ds_write_b128 v28, v[168:171]
    ds_write_b128 v28, v[172:175] offset:16
    ds_write_b128 v29, v[176:179] offset:2048
    ds_write_b128 v29, v[180:183] offset:3072
    v_lshlrev_b32 v6, 5, v3
    v_add_u32 v6, s36, v6
    v_and_b32 v28, 1, v2
    v_lshlrev_b32 v28, 10, v28
    v_lshl_add_u32 v28, v3, 4, v28
    v_add_u32 v7, s36, v28
    s_waitcnt lgkmcnt(0)
    ds_read_b128 v[8:11], v6 offset:0
    ds_read_b128 v[12:15], v6 offset:16
    ds_read_b128 v[16:19], v7 offset:2048
    s_waitcnt vmcnt(34)
    ds_read_b128 v[40:43], v26 offset:0
    ds_read_b128 v[44:47], v26 offset:2048
    ds_read_b128 v[48:51], v26 offset:4096
    ds_read_b128 v[52:55], v26 offset:6144
    s_waitcnt lgkmcnt(0)
    v_lshlrev_b32 v20, 16, v40
    v_and_b32 v21, s35, v40
    v_mul_f32 v20, v20, v8
    v_mul_f32 v21, v21, v9
    v_cvt_pk_bf16_f32 v40, v20, v21
    v_lshlrev_b32 v22, 16, v41
    v_and_b32 v23, s35, v41
    v_mul_f32 v22, v22, v10
    v_mul_f32 v23, v23, v11
    v_cvt_pk_bf16_f32 v41, v22, v23
    v_lshlrev_b32 v20, 16, v42
    v_and_b32 v21, s35, v42
    v_mul_f32 v20, v20, v12
    v_mul_f32 v21, v21, v13
    v_cvt_pk_bf16_f32 v42, v20, v21
    v_lshlrev_b32 v22, 16, v43
    v_and_b32 v23, s35, v43
    v_mul_f32 v22, v22, v14
    v_mul_f32 v23, v23, v15
    v_cvt_pk_bf16_f32 v43, v22, v23
    v_lshlrev_b32 v20, 16, v44
    v_and_b32 v21, s35, v44
    v_mul_f32 v20, v20, v8
    v_mul_f32 v21, v21, v9
    v_cvt_pk_bf16_f32 v44, v20, v21
    v_lshlrev_b32 v22, 16, v45
    v_and_b32 v23, s35, v45
    v_mul_f32 v22, v22, v10
    v_mul_f32 v23, v23, v11
    v_cvt_pk_bf16_f32 v45, v22, v23
    v_lshlrev_b32 v20, 16, v46
    v_and_b32 v21, s35, v46
    v_mul_f32 v20, v20, v12
    v_mul_f32 v21, v21, v13
    v_cvt_pk_bf16_f32 v46, v20, v21
    v_lshlrev_b32 v22, 16, v47
    v_and_b32 v23, s35, v47
    v_mul_f32 v22, v22, v14
    v_mul_f32 v23, v23, v15
    v_cvt_pk_bf16_f32 v47, v22, v23
    v_lshlrev_b32 v20, 16, v48
    v_and_b32 v21, s35, v48
    v_mul_f32 v20, v20, v8
    v_mul_f32 v21, v21, v9
    v_cvt_pk_bf16_f32 v48, v20, v21
    v_lshlrev_b32 v22, 16, v49
    v_and_b32 v23, s35, v49
    v_mul_f32 v22, v22, v10
    v_mul_f32 v23, v23, v11
    v_cvt_pk_bf16_f32 v49, v22, v23
    v_lshlrev_b32 v20, 16, v50
    v_and_b32 v21, s35, v50
    v_mul_f32 v20, v20, v12
    v_mul_f32 v21, v21, v13
    v_cvt_pk_bf16_f32 v50, v20, v21
    v_lshlrev_b32 v22, 16, v51
    v_and_b32 v23, s35, v51
    v_mul_f32 v22, v22, v14
    v_mul_f32 v23, v23, v15
    v_cvt_pk_bf16_f32 v51, v22, v23
    v_lshlrev_b32 v20, 16, v52
    v_and_b32 v21, s35, v52
    v_mul_f32 v20, v20, v8
    v_mul_f32 v21, v21, v9
    v_cvt_pk_bf16_f32 v52, v20, v21
    v_lshlrev_b32 v22, 16, v53
    v_and_b32 v23, s35, v53
    v_mul_f32 v22, v22, v10
    v_mul_f32 v23, v23, v11
    v_cvt_pk_bf16_f32 v53, v22, v23
    v_lshlrev_b32 v20, 16, v54
    v_and_b32 v21, s35, v54
    v_mul_f32 v20, v20, v12
    v_mul_f32 v21, v21, v13
    v_cvt_pk_bf16_f32 v54, v20, v21
    v_lshlrev_b32 v22, 16, v55
    v_and_b32 v23, s35, v55
    v_mul_f32 v22, v22, v14
    v_mul_f32 v23, v23, v15
    v_cvt_pk_bf16_f32 v55, v22, v23
    ds_read_b128 v[8:11], v6 offset:128
    ds_read_b128 v[12:15], v6 offset:144
    ds_read_b128 v[56:59], v27 offset:0
    ds_read_b128 v[60:63], v27 offset:2048
    ds_read_b128 v[64:67], v27 offset:4096
    ds_read_b128 v[68:71], v27 offset:6144
    s_add_u32 m0, s29, 24576
    s_add_u32 s34, s28, 384
    buffer_load_dwordx4 v24, s[12:15], s34 offen lds
    s_add_u32 m0, s29, 25600
    s_add_u32 s34, s28, 33152
    buffer_load_dwordx4 v25, s[12:15], s34 offen lds
    s_add_u32 m0, s29, 26624
    s_add_u32 s34, s28, 65920
    buffer_load_dwordx4 v24, s[12:15], s34 offen lds
    s_add_u32 m0, s29, 27648
    s_add_u32 s34, s28, 98688
    buffer_load_dwordx4 v25, s[12:15], s34 offen lds
    s_add_u32 m0, s29, 28672
    s_add_u32 s34, s28, 131456
    buffer_load_dwordx4 v24, s[12:15], s34 offen lds
    s_add_u32 m0, s29, 29696
    s_add_u32 s34, s28, 164224
    buffer_load_dwordx4 v25, s[12:15], s34 offen lds
    s_add_u32 m0, s29, 30720
    s_add_u32 s34, s28, 196992
    buffer_load_dwordx4 v24, s[12:15], s34 offen lds
    s_add_u32 m0, s29, 31744
    s_add_u32 s34, s28, 229760
    buffer_load_dwordx4 v25, s[12:15], s34 offen lds
    s_waitcnt vmcnt(36)
    v_mfma_f32_16x16x32_bf16 v[144:147], v[16:19], v[40:43], 0
    v_mfma_f32_16x16x32_bf16 v[148:151], v[16:19], v[44:47], 0
    v_mfma_f32_16x16x32_bf16 v[152:155], v[16:19], v[48:51], 0
    v_mfma_f32_16x16x32_bf16 v[156:159], v[16:19], v[52:55], 0
    ds_read_b128 v[16:19], v7 offset:2112
    v_mfma_f32_16x16x32_bf16 v[160:163], v[72:75], v[40:43], 0
    v_mfma_f32_16x16x32_bf16 v[164:167], v[72:75], v[44:47], 0
    v_mfma_f32_16x16x32_bf16 v[168:171], v[72:75], v[48:51], 0
    v_mfma_f32_16x16x32_bf16 v[172:175], v[72:75], v[52:55], 0
    s_waitcnt lgkmcnt(1)
    v_mfma_f32_16x16x32_bf16 v[176:179], v[76:79], v[40:43], 0
    v_lshlrev_b32 v20, 16, v56
    v_and_b32 v21, s35, v56
    v_mul_f32 v20, v20, v8
    v_mul_f32 v21, v21, v9
    v_mfma_f32_16x16x32_bf16 v[180:183], v[76:79], v[44:47], 0
    v_cvt_pk_bf16_f32 v56, v20, v21
    v_lshlrev_b32 v22, 16, v57
    v_and_b32 v23, s35, v57
    v_mul_f32 v22, v22, v10
    v_mfma_f32_16x16x32_bf16 v[184:187], v[76:79], v[48:51], 0
    v_mul_f32 v23, v23, v11
    v_cvt_pk_bf16_f32 v57, v22, v23
    v_lshlrev_b32 v20, 16, v58
    v_and_b32 v21, s35, v58
    v_mfma_f32_16x16x32_bf16 v[188:191], v[76:79], v[52:55], 0
    v_mul_f32 v20, v20, v12
    v_mul_f32 v21, v21, v13
    v_cvt_pk_bf16_f32 v58, v20, v21
    v_lshlrev_b32 v22, 16, v59
    v_mfma_f32_16x16x32_bf16 v[192:195], v[80:83], v[40:43], 0
    v_and_b32 v23, s35, v59
    v_mul_f32 v22, v22, v14
    v_mul_f32 v23, v23, v15
    v_cvt_pk_bf16_f32 v59, v22, v23
    v_mfma_f32_16x16x32_bf16 v[196:199], v[80:83], v[44:47], 0
    v_lshlrev_b32 v20, 16, v60
    v_and_b32 v21, s35, v60
    v_mul_f32 v20, v20, v8
    v_mul_f32 v21, v21, v9
    v_mfma_f32_16x16x32_bf16 v[200:203], v[80:83], v[48:51], 0
    v_cvt_pk_bf16_f32 v60, v20, v21
    v_lshlrev_b32 v22, 16, v61
    v_and_b32 v23, s35, v61
    v_mul_f32 v22, v22, v10
    v_mfma_f32_16x16x32_bf16 v[204:207], v[80:83], v[52:55], 0
    v_mul_f32 v23, v23, v11
    v_cvt_pk_bf16_f32 v61, v22, v23
    v_lshlrev_b32 v20, 16, v62
    v_and_b32 v21, s35, v62
    v_mfma_f32_16x16x32_bf16 v[208:211], v[84:87], v[40:43], 0
    v_mul_f32 v20, v20, v12
    v_mul_f32 v21, v21, v13
    v_cvt_pk_bf16_f32 v62, v20, v21
    v_lshlrev_b32 v22, 16, v63
    v_mfma_f32_16x16x32_bf16 v[212:215], v[84:87], v[44:47], 0
    v_and_b32 v23, s35, v63
    v_mul_f32 v22, v22, v14
    v_mul_f32 v23, v23, v15
    v_cvt_pk_bf16_f32 v63, v22, v23
    v_mfma_f32_16x16x32_bf16 v[216:219], v[84:87], v[48:51], 0
    v_lshlrev_b32 v20, 16, v64
    v_and_b32 v21, s35, v64
    v_mul_f32 v20, v20, v8
    v_mul_f32 v21, v21, v9
    v_mfma_f32_16x16x32_bf16 v[220:223], v[84:87], v[52:55], 0
    v_cvt_pk_bf16_f32 v64, v20, v21
    v_lshlrev_b32 v22, 16, v65
    v_and_b32 v23, s35, v65
    v_mul_f32 v22, v22, v10
    v_mfma_f32_16x16x32_bf16 v[224:227], v[88:91], v[40:43], 0
    v_mul_f32 v23, v23, v11
    v_cvt_pk_bf16_f32 v65, v22, v23
    v_lshlrev_b32 v20, 16, v66
    v_and_b32 v21, s35, v66
    v_mfma_f32_16x16x32_bf16 v[228:231], v[88:91], v[44:47], 0
    v_mul_f32 v20, v20, v12
    v_mul_f32 v21, v21, v13
    v_cvt_pk_bf16_f32 v66, v20, v21
    v_lshlrev_b32 v22, 16, v67
    v_mfma_f32_16x16x32_bf16 v[232:235], v[88:91], v[48:51], 0
    v_and_b32 v23, s35, v67
    v_mul_f32 v22, v22, v14
    v_mul_f32 v23, v23, v15
    v_cvt_pk_bf16_f32 v67, v22, v23
    v_mfma_f32_16x16x32_bf16 v[236:239], v[88:91], v[52:55], 0
    v_lshlrev_b32 v20, 16, v68
    v_and_b32 v21, s35, v68
    v_mul_f32 v20, v20, v8
    v_mul_f32 v21, v21, v9
    v_mfma_f32_16x16x32_bf16 v[240:243], v[92:95], v[40:43], 0
    v_cvt_pk_bf16_f32 v68, v20, v21
    v_lshlrev_b32 v22, 16, v69
    v_and_b32 v23, s35, v69
    v_mul_f32 v22, v22, v10
    v_mfma_f32_16x16x32_bf16 v[244:247], v[92:95], v[44:47], 0
    v_mul_f32 v23, v23, v11
    v_cvt_pk_bf16_f32 v69, v22, v23
    v_lshlrev_b32 v20, 16, v70
    v_and_b32 v21, s35, v70
    v_mfma_f32_16x16x32_bf16 v[248:251], v[92:95], v[48:51], 0
    v_mul_f32 v20, v20, v12
    v_mul_f32 v21, v21, v13
    v_cvt_pk_bf16_f32 v70, v20, v21
    v_lshlrev_b32 v22, 16, v71
    v_mfma_f32_16x16x32_bf16 v[252:255], v[92:95], v[52:55], 0
    v_and_b32 v23, s35, v71
    v_mul_f32 v22, v22, v14
    v_mul_f32 v23, v23, v15
    v_cvt_pk_bf16_f32 v71, v22, v23
    ds_read_b128 v[8:11], v6 offset:256
    ds_read_b128 v[12:15], v6 offset:272
    s_waitcnt vmcnt(22)
    ds_read_b128 v[40:43], v26 offset:8192
    ds_read_b128 v[44:47], v26 offset:10240
    ds_read_b128 v[48:51], v26 offset:12288
    ds_read_b128 v[52:55], v26 offset:14336
    s_waitcnt lgkmcnt(6)
    s_add_u32 m0, s29, 0
    s_add_u32 s34, s28, 512
    buffer_load_dwordx4 v24, s[12:15], s34 offen lds
    s_add_u32 m0, s29, 1024
    s_add_u32 s34, s28, 33280
    buffer_load_dwordx4 v25, s[12:15], s34 offen lds
    s_add_u32 m0, s29, 2048
    s_add_u32 s34, s28, 66048
    buffer_load_dwordx4 v24, s[12:15], s34 offen lds
    s_add_u32 m0, s29, 3072
    s_add_u32 s34, s28, 98816
    buffer_load_dwordx4 v25, s[12:15], s34 offen lds
    s_add_u32 m0, s29, 4096
    s_add_u32 s34, s28, 131584
    buffer_load_dwordx4 v24, s[12:15], s34 offen lds
    s_add_u32 m0, s29, 5120
    s_add_u32 s34, s28, 164352
    buffer_load_dwordx4 v25, s[12:15], s34 offen lds
    s_add_u32 m0, s29, 6144
    s_add_u32 s34, s28, 197120
    buffer_load_dwordx4 v24, s[12:15], s34 offen lds
    s_add_u32 m0, s29, 7168
    s_add_u32 s34, s28, 229888
    buffer_load_dwordx4 v25, s[12:15], s34 offen lds
    buffer_load_dwordx4 v[72:75], v4, s[20:23], s27 offen offset:0
    buffer_load_dwordx4 v[76:79], v4, s[20:23], s27 offen offset:1024
    buffer_load_dwordx4 v[80:83], v4, s[20:23], s27 offen offset:2048
    buffer_load_dwordx4 v[84:87], v4, s[20:23], s27 offen offset:3072
    buffer_load_dwordx4 v[88:91], v5, s[20:23], s27 offen offset:0
    buffer_load_dwordx4 v[92:95], v5, s[20:23], s27 offen offset:1024
    s_add_u32 s27, s27, 6144
    s_waitcnt vmcnt(44)
    v_mfma_f32_16x16x32_bf16 v[144:147], v[16:19], v[56:59], v[144:147]
    v_mfma_f32_16x16x32_bf16 v[148:151], v[16:19], v[60:63], v[148:151]
    v_mfma_f32_16x16x32_bf16 v[152:155], v[16:19], v[64:67], v[152:155]
    v_mfma_f32_16x16x32_bf16 v[156:159], v[16:19], v[68:71], v[156:159]
    ds_read_b128 v[16:19], v7 offset:2176
    v_mfma_f32_16x16x32_bf16 v[160:163], v[96:99], v[56:59], v[160:163]
    v_mfma_f32_16x16x32_bf16 v[164:167], v[96:99], v[60:63], v[164:167]
    v_mfma_f32_16x16x32_bf16 v[168:171], v[96:99], v[64:67], v[168:171]
    v_mfma_f32_16x16x32_bf16 v[172:175], v[96:99], v[68:71], v[172:175]
    s_waitcnt lgkmcnt(1)
    v_mfma_f32_16x16x32_bf16 v[176:179], v[100:103], v[56:59], v[176:179]
    v_lshlrev_b32 v20, 16, v40
    v_and_b32 v21, s35, v40
    v_mul_f32 v20, v20, v8
    v_mul_f32 v21, v21, v9
    v_mfma_f32_16x16x32_bf16 v[180:183], v[100:103], v[60:63], v[180:183]
    v_cvt_pk_bf16_f32 v40, v20, v21
    v_lshlrev_b32 v22, 16, v41
    v_and_b32 v23, s35, v41
    v_mul_f32 v22, v22, v10
    v_mfma_f32_16x16x32_bf16 v[184:187], v[100:103], v[64:67], v[184:187]
    v_mul_f32 v23, v23, v11
    v_cvt_pk_bf16_f32 v41, v22, v23
    v_lshlrev_b32 v20, 16, v42
    v_and_b32 v21, s35, v42
    v_mfma_f32_16x16x32_bf16 v[188:191], v[100:103], v[68:71], v[188:191]
    v_mul_f32 v20, v20, v12
    v_mul_f32 v21, v21, v13
    v_cvt_pk_bf16_f32 v42, v20, v21
    v_lshlrev_b32 v22, 16, v43
    v_mfma_f32_16x16x32_bf16 v[192:195], v[104:107], v[56:59], v[192:195]
    v_and_b32 v23, s35, v43
    v_mul_f32 v22, v22, v14
    v_mul_f32 v23, v23, v15
    v_cvt_pk_bf16_f32 v43, v22, v23
    v_mfma_f32_16x16x32_bf16 v[196:199], v[104:107], v[60:63], v[196:199]
    v_lshlrev_b32 v20, 16, v44
    v_and_b32 v21, s35, v44
    v_mul_f32 v20, v20, v8
    v_mul_f32 v21, v21, v9
    v_mfma_f32_16x16x32_bf16 v[200:203], v[104:107], v[64:67], v[200:203]
    v_cvt_pk_bf16_f32 v44, v20, v21
    v_lshlrev_b32 v22, 16, v45
    v_and_b32 v23, s35, v45
    v_mul_f32 v22, v22, v10
    v_mfma_f32_16x16x32_bf16 v[204:207], v[104:107], v[68:71], v[204:207]
    v_mul_f32 v23, v23, v11
    v_cvt_pk_bf16_f32 v45, v22, v23
    v_lshlrev_b32 v20, 16, v46
    v_and_b32 v21, s35, v46
    v_mfma_f32_16x16x32_bf16 v[208:211], v[108:111], v[56:59], v[208:211]
    v_mul_f32 v20, v20, v12
    v_mul_f32 v21, v21, v13
    v_cvt_pk_bf16_f32 v46, v20, v21
    v_lshlrev_b32 v22, 16, v47
    v_mfma_f32_16x16x32_bf16 v[212:215], v[108:111], v[60:63], v[212:215]
    v_and_b32 v23, s35, v47
    v_mul_f32 v22, v22, v14
    v_mul_f32 v23, v23, v15
    v_cvt_pk_bf16_f32 v47, v22, v23
    v_mfma_f32_16x16x32_bf16 v[216:219], v[108:111], v[64:67], v[216:219]
    v_lshlrev_b32 v20, 16, v48
    v_and_b32 v21, s35, v48
    v_mul_f32 v20, v20, v8
    v_mul_f32 v21, v21, v9
    v_mfma_f32_16x16x32_bf16 v[220:223], v[108:111], v[68:71], v[220:223]
    v_cvt_pk_bf16_f32 v48, v20, v21
    v_lshlrev_b32 v22, 16, v49
    v_and_b32 v23, s35, v49
    v_mul_f32 v22, v22, v10
    v_mfma_f32_16x16x32_bf16 v[224:227], v[112:115], v[56:59], v[224:227]
    v_mul_f32 v23, v23, v11
    v_cvt_pk_bf16_f32 v49, v22, v23
    v_lshlrev_b32 v20, 16, v50
    v_and_b32 v21, s35, v50
    v_mfma_f32_16x16x32_bf16 v[228:231], v[112:115], v[60:63], v[228:231]
    v_mul_f32 v20, v20, v12
    v_mul_f32 v21, v21, v13
    v_cvt_pk_bf16_f32 v50, v20, v21
    v_lshlrev_b32 v22, 16, v51
    v_mfma_f32_16x16x32_bf16 v[232:235], v[112:115], v[64:67], v[232:235]
    v_and_b32 v23, s35, v51
    v_mul_f32 v22, v22, v14
    v_mul_f32 v23, v23, v15
    v_cvt_pk_bf16_f32 v51, v22, v23
    v_mfma_f32_16x16x32_bf16 v[236:239], v[112:115], v[68:71], v[236:239]
    v_lshlrev_b32 v20, 16, v52
    v_and_b32 v21, s35, v52
    v_mul_f32 v20, v20, v8
    v_mul_f32 v21, v21, v9
    v_mfma_f32_16x16x32_bf16 v[240:243], v[116:119], v[56:59], v[240:243]
    v_cvt_pk_bf16_f32 v52, v20, v21
    v_lshlrev_b32 v22, 16, v53
    v_and_b32 v23, s35, v53
    v_mul_f32 v22, v22, v10
    v_mfma_f32_16x16x32_bf16 v[244:247], v[116:119], v[60:63], v[244:247]
    v_mul_f32 v23, v23, v11
    v_cvt_pk_bf16_f32 v53, v22, v23
    v_lshlrev_b32 v20, 16, v54
    v_and_b32 v21, s35, v54
    v_mfma_f32_16x16x32_bf16 v[248:251], v[116:119], v[64:67], v[248:251]
    v_mul_f32 v20, v20, v12
    v_mul_f32 v21, v21, v13
    v_cvt_pk_bf16_f32 v54, v20, v21
    v_lshlrev_b32 v22, 16, v55
    v_mfma_f32_16x16x32_bf16 v[252:255], v[116:119], v[68:71], v[252:255]
    v_and_b32 v23, s35, v55
    v_mul_f32 v22, v22, v14
    v_mul_f32 v23, v23, v15
    v_cvt_pk_bf16_f32 v55, v22, v23
    ds_read_b128 v[8:11], v6 offset:384
    ds_read_b128 v[12:15], v6 offset:400
    ds_read_b128 v[56:59], v27 offset:8192
    ds_read_b128 v[60:63], v27 offset:10240
    ds_read_b128 v[64:67], v27 offset:12288
    ds_read_b128 v[68:71], v27 offset:14336
    s_waitcnt lgkmcnt(6)
    buffer_load_dwordx4 v[96:99], v4, s[20:23], s27 offen offset:0
    buffer_load_dwordx4 v[100:103], v4, s[20:23], s27 offen offset:1024
    buffer_load_dwordx4 v[104:107], v4, s[20:23], s27 offen offset:2048
    buffer_load_dwordx4 v[108:111], v4, s[20:23], s27 offen offset:3072
    buffer_load_dwordx4 v[112:115], v5, s[20:23], s27 offen offset:0
    buffer_load_dwordx4 v[116:119], v5, s[20:23], s27 offen offset:1024
    s_add_u32 s27, s27, 6144
    s_waitcnt vmcnt(36)
    v_mfma_f32_16x16x32_bf16 v[144:147], v[16:19], v[40:43], v[144:147]
    v_mfma_f32_16x16x32_bf16 v[148:151], v[16:19], v[44:47], v[148:151]
    v_mfma_f32_16x16x32_bf16 v[152:155], v[16:19], v[48:51], v[152:155]
    v_mfma_f32_16x16x32_bf16 v[156:159], v[16:19], v[52:55], v[156:159]
    ds_read_b128 v[16:19], v7 offset:2240
    v_mfma_f32_16x16x32_bf16 v[160:163], v[120:123], v[40:43], v[160:163]
    v_mfma_f32_16x16x32_bf16 v[164:167], v[120:123], v[44:47], v[164:167]
    v_mfma_f32_16x16x32_bf16 v[168:171], v[120:123], v[48:51], v[168:171]
    v_mfma_f32_16x16x32_bf16 v[172:175], v[120:123], v[52:55], v[172:175]
    s_waitcnt lgkmcnt(1)
    v_mfma_f32_16x16x32_bf16 v[176:179], v[124:127], v[40:43], v[176:179]
    v_lshlrev_b32 v20, 16, v56
    v_and_b32 v21, s35, v56
    v_mul_f32 v20, v20, v8
    v_mul_f32 v21, v21, v9
    v_mfma_f32_16x16x32_bf16 v[180:183], v[124:127], v[44:47], v[180:183]
    v_cvt_pk_bf16_f32 v56, v20, v21
    v_lshlrev_b32 v22, 16, v57
    v_and_b32 v23, s35, v57
    v_mul_f32 v22, v22, v10
    v_mfma_f32_16x16x32_bf16 v[184:187], v[124:127], v[48:51], v[184:187]
    v_mul_f32 v23, v23, v11
    v_cvt_pk_bf16_f32 v57, v22, v23
    v_lshlrev_b32 v20, 16, v58
    v_and_b32 v21, s35, v58
    v_mfma_f32_16x16x32_bf16 v[188:191], v[124:127], v[52:55], v[188:191]
    v_mul_f32 v20, v20, v12
    v_mul_f32 v21, v21, v13
    v_cvt_pk_bf16_f32 v58, v20, v21
    v_lshlrev_b32 v22, 16, v59
    v_mfma_f32_16x16x32_bf16 v[192:195], v[128:131], v[40:43], v[192:195]
    v_and_b32 v23, s35, v59
    v_mul_f32 v22, v22, v14
    v_mul_f32 v23, v23, v15
    v_cvt_pk_bf16_f32 v59, v22, v23
    v_mfma_f32_16x16x32_bf16 v[196:199], v[128:131], v[44:47], v[196:199]
    v_lshlrev_b32 v20, 16, v60
    v_and_b32 v21, s35, v60
    v_mul_f32 v20, v20, v8
    v_mul_f32 v21, v21, v9
    v_mfma_f32_16x16x32_bf16 v[200:203], v[128:131], v[48:51], v[200:203]
    v_cvt_pk_bf16_f32 v60, v20, v21
    v_lshlrev_b32 v22, 16, v61
    v_and_b32 v23, s35, v61
    v_mul_f32 v22, v22, v10
    v_mfma_f32_16x16x32_bf16 v[204:207], v[128:131], v[52:55], v[204:207]
    v_mul_f32 v23, v23, v11
    v_cvt_pk_bf16_f32 v61, v22, v23
    v_lshlrev_b32 v20, 16, v62
    v_and_b32 v21, s35, v62
    v_mfma_f32_16x16x32_bf16 v[208:211], v[132:135], v[40:43], v[208:211]
    v_mul_f32 v20, v20, v12
    v_mul_f32 v21, v21, v13
    v_cvt_pk_bf16_f32 v62, v20, v21
    v_lshlrev_b32 v22, 16, v63
    v_mfma_f32_16x16x32_bf16 v[212:215], v[132:135], v[44:47], v[212:215]
    v_and_b32 v23, s35, v63
    v_mul_f32 v22, v22, v14
    v_mul_f32 v23, v23, v15
    v_cvt_pk_bf16_f32 v63, v22, v23
    v_mfma_f32_16x16x32_bf16 v[216:219], v[132:135], v[48:51], v[216:219]
    v_lshlrev_b32 v20, 16, v64
    v_and_b32 v21, s35, v64
    v_mul_f32 v20, v20, v8
    v_mul_f32 v21, v21, v9
    v_mfma_f32_16x16x32_bf16 v[220:223], v[132:135], v[52:55], v[220:223]
    v_cvt_pk_bf16_f32 v64, v20, v21
    v_lshlrev_b32 v22, 16, v65
    v_and_b32 v23, s35, v65
    v_mul_f32 v22, v22, v10
    v_mfma_f32_16x16x32_bf16 v[224:227], v[136:139], v[40:43], v[224:227]
    v_mul_f32 v23, v23, v11
    v_cvt_pk_bf16_f32 v65, v22, v23
    v_lshlrev_b32 v20, 16, v66
    v_and_b32 v21, s35, v66
    v_mfma_f32_16x16x32_bf16 v[228:231], v[136:139], v[44:47], v[228:231]
    v_mul_f32 v20, v20, v12
    v_mul_f32 v21, v21, v13
    v_cvt_pk_bf16_f32 v66, v20, v21
    v_lshlrev_b32 v22, 16, v67
    v_mfma_f32_16x16x32_bf16 v[232:235], v[136:139], v[48:51], v[232:235]
    v_and_b32 v23, s35, v67
    v_mul_f32 v22, v22, v14
    v_mul_f32 v23, v23, v15
    v_cvt_pk_bf16_f32 v67, v22, v23
    v_mfma_f32_16x16x32_bf16 v[236:239], v[136:139], v[52:55], v[236:239]
    v_lshlrev_b32 v20, 16, v68
    v_and_b32 v21, s35, v68
    v_mul_f32 v20, v20, v8
    v_mul_f32 v21, v21, v9
    v_mfma_f32_16x16x32_bf16 v[240:243], v[140:143], v[40:43], v[240:243]
    v_cvt_pk_bf16_f32 v68, v20, v21
    v_lshlrev_b32 v22, 16, v69
    v_and_b32 v23, s35, v69
    v_mul_f32 v22, v22, v10
    v_mfma_f32_16x16x32_bf16 v[244:247], v[140:143], v[44:47], v[244:247]
    v_mul_f32 v23, v23, v11
    v_cvt_pk_bf16_f32 v69, v22, v23
    v_lshlrev_b32 v20, 16, v70
    v_and_b32 v21, s35, v70
    v_mfma_f32_16x16x32_bf16 v[248:251], v[140:143], v[48:51], v[248:251]
    v_mul_f32 v20, v20, v12
    v_mul_f32 v21, v21, v13
    v_cvt_pk_bf16_f32 v70, v20, v21
    v_lshlrev_b32 v22, 16, v71
    v_mfma_f32_16x16x32_bf16 v[252:255], v[140:143], v[52:55], v[252:255]
    v_and_b32 v23, s35, v71
    v_mul_f32 v22, v22, v14
    v_mul_f32 v23, v23, v15
    v_cvt_pk_bf16_f32 v71, v22, v23
    ds_read_b128 v[8:11], v6 offset:512
    ds_read_b128 v[12:15], v6 offset:528
    s_waitcnt vmcnt(28)
    ds_read_b128 v[40:43], v26 offset:16384
    ds_read_b128 v[44:47], v26 offset:18432
    ds_read_b128 v[48:51], v26 offset:20480
    ds_read_b128 v[52:55], v26 offset:22528
    s_waitcnt lgkmcnt(6)
    s_add_u32 m0, s29, 8192
    s_add_u32 s34, s28, 640
    buffer_load_dwordx4 v24, s[12:15], s34 offen lds
    s_add_u32 m0, s29, 9216
    s_add_u32 s34, s28, 33408
    buffer_load_dwordx4 v25, s[12:15], s34 offen lds
    s_add_u32 m0, s29, 10240
    s_add_u32 s34, s28, 66176
    buffer_load_dwordx4 v24, s[12:15], s34 offen lds
    s_add_u32 m0, s29, 11264
    s_add_u32 s34, s28, 98944
    buffer_load_dwordx4 v25, s[12:15], s34 offen lds
    s_add_u32 m0, s29, 12288
    s_add_u32 s34, s28, 131712
    buffer_load_dwordx4 v24, s[12:15], s34 offen lds
    s_add_u32 m0, s29, 13312
    s_add_u32 s34, s28, 164480
    buffer_load_dwordx4 v25, s[12:15], s34 offen lds
    s_add_u32 m0, s29, 14336
    s_add_u32 s34, s28, 197248
    buffer_load_dwordx4 v24, s[12:15], s34 offen lds
    s_add_u32 m0, s29, 15360
    s_add_u32 s34, s28, 230016
    buffer_load_dwordx4 v25, s[12:15], s34 offen lds
    buffer_load_dwordx4 v[120:123], v4, s[20:23], s27 offen offset:0
    buffer_load_dwordx4 v[124:127], v4, s[20:23], s27 offen offset:1024
    buffer_load_dwordx4 v[128:131], v4, s[20:23], s27 offen offset:2048
    buffer_load_dwordx4 v[132:135], v4, s[20:23], s27 offen offset:3072
    buffer_load_dwordx4 v[136:139], v5, s[20:23], s27 offen offset:0
    buffer_load_dwordx4 v[140:143], v5, s[20:23], s27 offen offset:1024
    s_add_u32 s27, s27, 6144
    s_waitcnt vmcnt(20)
    v_mfma_f32_16x16x32_bf16 v[144:147], v[16:19], v[56:59], v[144:147]
    v_mfma_f32_16x16x32_bf16 v[148:151], v[16:19], v[60:63], v[148:151]
    v_mfma_f32_16x16x32_bf16 v[152:155], v[16:19], v[64:67], v[152:155]
    v_mfma_f32_16x16x32_bf16 v[156:159], v[16:19], v[68:71], v[156:159]
    ds_read_b128 v[16:19], v7 offset:2304
    v_mfma_f32_16x16x32_bf16 v[160:163], v[72:75], v[56:59], v[160:163]
    v_mfma_f32_16x16x32_bf16 v[164:167], v[72:75], v[60:63], v[164:167]
    v_mfma_f32_16x16x32_bf16 v[168:171], v[72:75], v[64:67], v[168:171]
    v_mfma_f32_16x16x32_bf16 v[172:175], v[72:75], v[68:71], v[172:175]
    s_waitcnt lgkmcnt(1)
    v_mfma_f32_16x16x32_bf16 v[176:179], v[76:79], v[56:59], v[176:179]
    v_lshlrev_b32 v20, 16, v40
    v_and_b32 v21, s35, v40
    v_mul_f32 v20, v20, v8
    v_mul_f32 v21, v21, v9
    v_mfma_f32_16x16x32_bf16 v[180:183], v[76:79], v[60:63], v[180:183]
    v_cvt_pk_bf16_f32 v40, v20, v21
    v_lshlrev_b32 v22, 16, v41
    v_and_b32 v23, s35, v41
    v_mul_f32 v22, v22, v10
    v_mfma_f32_16x16x32_bf16 v[184:187], v[76:79], v[64:67], v[184:187]
    v_mul_f32 v23, v23, v11
    v_cvt_pk_bf16_f32 v41, v22, v23
    v_lshlrev_b32 v20, 16, v42
    v_and_b32 v21, s35, v42
    v_mfma_f32_16x16x32_bf16 v[188:191], v[76:79], v[68:71], v[188:191]
    v_mul_f32 v20, v20, v12
    v_mul_f32 v21, v21, v13
    v_cvt_pk_bf16_f32 v42, v20, v21
    v_lshlrev_b32 v22, 16, v43
    v_mfma_f32_16x16x32_bf16 v[192:195], v[80:83], v[56:59], v[192:195]
    v_and_b32 v23, s35, v43
    v_mul_f32 v22, v22, v14
    v_mul_f32 v23, v23, v15
    v_cvt_pk_bf16_f32 v43, v22, v23
    v_mfma_f32_16x16x32_bf16 v[196:199], v[80:83], v[60:63], v[196:199]
    v_lshlrev_b32 v20, 16, v44
    v_and_b32 v21, s35, v44
    v_mul_f32 v20, v20, v8
    v_mul_f32 v21, v21, v9
    v_mfma_f32_16x16x32_bf16 v[200:203], v[80:83], v[64:67], v[200:203]
    v_cvt_pk_bf16_f32 v44, v20, v21
    v_lshlrev_b32 v22, 16, v45
    v_and_b32 v23, s35, v45
    v_mul_f32 v22, v22, v10
    v_mfma_f32_16x16x32_bf16 v[204:207], v[80:83], v[68:71], v[204:207]
    v_mul_f32 v23, v23, v11
    v_cvt_pk_bf16_f32 v45, v22, v23
    v_lshlrev_b32 v20, 16, v46
    v_and_b32 v21, s35, v46
    v_mfma_f32_16x16x32_bf16 v[208:211], v[84:87], v[56:59], v[208:211]
    v_mul_f32 v20, v20, v12
    v_mul_f32 v21, v21, v13
    v_cvt_pk_bf16_f32 v46, v20, v21
    v_lshlrev_b32 v22, 16, v47
    v_mfma_f32_16x16x32_bf16 v[212:215], v[84:87], v[60:63], v[212:215]
    v_and_b32 v23, s35, v47
    v_mul_f32 v22, v22, v14
    v_mul_f32 v23, v23, v15
    v_cvt_pk_bf16_f32 v47, v22, v23
    v_mfma_f32_16x16x32_bf16 v[216:219], v[84:87], v[64:67], v[216:219]
    v_lshlrev_b32 v20, 16, v48
    v_and_b32 v21, s35, v48
    v_mul_f32 v20, v20, v8
    v_mul_f32 v21, v21, v9
    v_mfma_f32_16x16x32_bf16 v[220:223], v[84:87], v[68:71], v[220:223]
    v_cvt_pk_bf16_f32 v48, v20, v21
    v_lshlrev_b32 v22, 16, v49
    v_and_b32 v23, s35, v49
    v_mul_f32 v22, v22, v10
    v_mfma_f32_16x16x32_bf16 v[224:227], v[88:91], v[56:59], v[224:227]
    v_mul_f32 v23, v23, v11
    v_cvt_pk_bf16_f32 v49, v22, v23
    v_lshlrev_b32 v20, 16, v50
    v_and_b32 v21, s35, v50
    v_mfma_f32_16x16x32_bf16 v[228:231], v[88:91], v[60:63], v[228:231]
    v_mul_f32 v20, v20, v12
    v_mul_f32 v21, v21, v13
    v_cvt_pk_bf16_f32 v50, v20, v21
    v_lshlrev_b32 v22, 16, v51
    v_mfma_f32_16x16x32_bf16 v[232:235], v[88:91], v[64:67], v[232:235]
    v_and_b32 v23, s35, v51
    v_mul_f32 v22, v22, v14
    v_mul_f32 v23, v23, v15
    v_cvt_pk_bf16_f32 v51, v22, v23
    v_mfma_f32_16x16x32_bf16 v[236:239], v[88:91], v[68:71], v[236:239]
    v_lshlrev_b32 v20, 16, v52
    v_and_b32 v21, s35, v52
    v_mul_f32 v20, v20, v8
    v_mul_f32 v21, v21, v9
    v_mfma_f32_16x16x32_bf16 v[240:243], v[92:95], v[56:59], v[240:243]
    v_cvt_pk_bf16_f32 v52, v20, v21
    v_lshlrev_b32 v22, 16, v53
    v_and_b32 v23, s35, v53
    v_mul_f32 v22, v22, v10
    v_mfma_f32_16x16x32_bf16 v[244:247], v[92:95], v[60:63], v[244:247]
    v_mul_f32 v23, v23, v11
    v_cvt_pk_bf16_f32 v53, v22, v23
    v_lshlrev_b32 v20, 16, v54
    v_and_b32 v21, s35, v54
    v_mfma_f32_16x16x32_bf16 v[248:251], v[92:95], v[64:67], v[248:251]
    v_mul_f32 v20, v20, v12
    v_mul_f32 v21, v21, v13
    v_cvt_pk_bf16_f32 v54, v20, v21
    v_lshlrev_b32 v22, 16, v55
    v_mfma_f32_16x16x32_bf16 v[252:255], v[92:95], v[68:71], v[252:255]
    v_and_b32 v23, s35, v55
    v_mul_f32 v22, v22, v14
    v_mul_f32 v23, v23, v15
    v_cvt_pk_bf16_f32 v55, v22, v23
    ds_read_b128 v[8:11], v6 offset:640
    ds_read_b128 v[12:15], v6 offset:656
    ds_read_b128 v[56:59], v27 offset:16384
    ds_read_b128 v[60:63], v27 offset:18432
    ds_read_b128 v[64:67], v27 offset:20480
    ds_read_b128 v[68:71], v27 offset:22528
    s_waitcnt lgkmcnt(6)
    buffer_load_dwordx4 v[72:75], v4, s[20:23], s27 offen offset:0
    buffer_load_dwordx4 v[76:79], v4, s[20:23], s27 offen offset:1024
    buffer_load_dwordx4 v[80:83], v4, s[20:23], s27 offen offset:2048
    buffer_load_dwordx4 v[84:87], v4, s[20:23], s27 offen offset:3072
    buffer_load_dwordx4 v[88:91], v5, s[20:23], s27 offen offset:0
    buffer_load_dwordx4 v[92:95], v5, s[20:23], s27 offen offset:1024
    s_add_u32 s27, s27, 6144
    s_waitcnt vmcnt(20)
    v_mfma_f32_16x16x32_bf16 v[144:147], v[16:19], v[40:43], v[144:147]
    v_mfma_f32_16x16x32_bf16 v[148:151], v[16:19], v[44:47], v[148:151]
    v_mfma_f32_16x16x32_bf16 v[152:155], v[16:19], v[48:51], v[152:155]
    v_mfma_f32_16x16x32_bf16 v[156:159], v[16:19], v[52:55], v[156:159]
    ds_read_b128 v[16:19], v7 offset:2368
    v_mfma_f32_16x16x32_bf16 v[160:163], v[96:99], v[40:43], v[160:163]
    v_mfma_f32_16x16x32_bf16 v[164:167], v[96:99], v[44:47], v[164:167]
    v_mfma_f32_16x16x32_bf16 v[168:171], v[96:99], v[48:51], v[168:171]
    v_mfma_f32_16x16x32_bf16 v[172:175], v[96:99], v[52:55], v[172:175]
    s_waitcnt lgkmcnt(1)
    v_mfma_f32_16x16x32_bf16 v[176:179], v[100:103], v[40:43], v[176:179]
    v_lshlrev_b32 v20, 16, v56
    v_and_b32 v21, s35, v56
    v_mul_f32 v20, v20, v8
    v_mul_f32 v21, v21, v9
    v_mfma_f32_16x16x32_bf16 v[180:183], v[100:103], v[44:47], v[180:183]
    v_cvt_pk_bf16_f32 v56, v20, v21
    v_lshlrev_b32 v22, 16, v57
    v_and_b32 v23, s35, v57
    v_mul_f32 v22, v22, v10
    v_mfma_f32_16x16x32_bf16 v[184:187], v[100:103], v[48:51], v[184:187]
    v_mul_f32 v23, v23, v11
    v_cvt_pk_bf16_f32 v57, v22, v23
    v_lshlrev_b32 v20, 16, v58
    v_and_b32 v21, s35, v58
    v_mfma_f32_16x16x32_bf16 v[188:191], v[100:103], v[52:55], v[188:191]
    v_mul_f32 v20, v20, v12
    v_mul_f32 v21, v21, v13
    v_cvt_pk_bf16_f32 v58, v20, v21
    v_lshlrev_b32 v22, 16, v59
    v_mfma_f32_16x16x32_bf16 v[192:195], v[104:107], v[40:43], v[192:195]
    v_and_b32 v23, s35, v59
    v_mul_f32 v22, v22, v14
    v_mul_f32 v23, v23, v15
    v_cvt_pk_bf16_f32 v59, v22, v23
    v_mfma_f32_16x16x32_bf16 v[196:199], v[104:107], v[44:47], v[196:199]
    v_lshlrev_b32 v20, 16, v60
    v_and_b32 v21, s35, v60
    v_mul_f32 v20, v20, v8
    v_mul_f32 v21, v21, v9
    v_mfma_f32_16x16x32_bf16 v[200:203], v[104:107], v[48:51], v[200:203]
    v_cvt_pk_bf16_f32 v60, v20, v21
    v_lshlrev_b32 v22, 16, v61
    v_and_b32 v23, s35, v61
    v_mul_f32 v22, v22, v10
    v_mfma_f32_16x16x32_bf16 v[204:207], v[104:107], v[52:55], v[204:207]
    v_mul_f32 v23, v23, v11
    v_cvt_pk_bf16_f32 v61, v22, v23
    v_lshlrev_b32 v20, 16, v62
    v_and_b32 v21, s35, v62
    v_mfma_f32_16x16x32_bf16 v[208:211], v[108:111], v[40:43], v[208:211]
    v_mul_f32 v20, v20, v12
    v_mul_f32 v21, v21, v13
    v_cvt_pk_bf16_f32 v62, v20, v21
    v_lshlrev_b32 v22, 16, v63
    v_mfma_f32_16x16x32_bf16 v[212:215], v[108:111], v[44:47], v[212:215]
    v_and_b32 v23, s35, v63
    v_mul_f32 v22, v22, v14
    v_mul_f32 v23, v23, v15
    v_cvt_pk_bf16_f32 v63, v22, v23
    v_mfma_f32_16x16x32_bf16 v[216:219], v[108:111], v[48:51], v[216:219]
    v_lshlrev_b32 v20, 16, v64
    v_and_b32 v21, s35, v64
    v_mul_f32 v20, v20, v8
    v_mul_f32 v21, v21, v9
    v_mfma_f32_16x16x32_bf16 v[220:223], v[108:111], v[52:55], v[220:223]
    v_cvt_pk_bf16_f32 v64, v20, v21
    v_lshlrev_b32 v22, 16, v65
    v_and_b32 v23, s35, v65
    v_mul_f32 v22, v22, v10
    v_mfma_f32_16x16x32_bf16 v[224:227], v[112:115], v[40:43], v[224:227]
    v_mul_f32 v23, v23, v11
    v_cvt_pk_bf16_f32 v65, v22, v23
    v_lshlrev_b32 v20, 16, v66
    v_and_b32 v21, s35, v66
    v_mfma_f32_16x16x32_bf16 v[228:231], v[112:115], v[44:47], v[228:231]
    v_mul_f32 v20, v20, v12
    v_mul_f32 v21, v21, v13
    v_cvt_pk_bf16_f32 v66, v20, v21
    v_lshlrev_b32 v22, 16, v67
    v_mfma_f32_16x16x32_bf16 v[232:235], v[112:115], v[48:51], v[232:235]
    v_and_b32 v23, s35, v67
    v_mul_f32 v22, v22, v14
    v_mul_f32 v23, v23, v15
    v_cvt_pk_bf16_f32 v67, v22, v23
    v_mfma_f32_16x16x32_bf16 v[236:239], v[112:115], v[52:55], v[236:239]
    v_lshlrev_b32 v20, 16, v68
    v_and_b32 v21, s35, v68
    v_mul_f32 v20, v20, v8
    v_mul_f32 v21, v21, v9
    v_mfma_f32_16x16x32_bf16 v[240:243], v[116:119], v[40:43], v[240:243]
    v_cvt_pk_bf16_f32 v68, v20, v21
    v_lshlrev_b32 v22, 16, v69
    v_and_b32 v23, s35, v69
    v_mul_f32 v22, v22, v10
    v_mfma_f32_16x16x32_bf16 v[244:247], v[116:119], v[44:47], v[244:247]
    v_mul_f32 v23, v23, v11
    v_cvt_pk_bf16_f32 v69, v22, v23
    v_lshlrev_b32 v20, 16, v70
    v_and_b32 v21, s35, v70
    v_mfma_f32_16x16x32_bf16 v[248:251], v[116:119], v[48:51], v[248:251]
    v_mul_f32 v20, v20, v12
    v_mul_f32 v21, v21, v13
    v_cvt_pk_bf16_f32 v70, v20, v21
    v_lshlrev_b32 v22, 16, v71
    v_mfma_f32_16x16x32_bf16 v[252:255], v[116:119], v[52:55], v[252:255]
    v_and_b32 v23, s35, v71
    v_mul_f32 v22, v22, v14
    v_mul_f32 v23, v23, v15
    v_cvt_pk_bf16_f32 v71, v22, v23
    ds_read_b128 v[8:11], v6 offset:768
    ds_read_b128 v[12:15], v6 offset:784
    s_waitcnt vmcnt(40)
    ds_read_b128 v[40:43], v26 offset:24576
    ds_read_b128 v[44:47], v26 offset:26624
    ds_read_b128 v[48:51], v26 offset:28672
    ds_read_b128 v[52:55], v26 offset:30720
    s_waitcnt lgkmcnt(6)
    s_add_u32 m0, s29, 16384
    s_add_u32 s34, s28, 768
    buffer_load_dwordx4 v24, s[12:15], s34 offen lds
    s_add_u32 m0, s29, 17408
    s_add_u32 s34, s28, 33536
    buffer_load_dwordx4 v25, s[12:15], s34 offen lds
    s_add_u32 m0, s29, 18432
    s_add_u32 s34, s28, 66304
    buffer_load_dwordx4 v24, s[12:15], s34 offen lds
    s_add_u32 m0, s29, 19456
    s_add_u32 s34, s28, 99072
    buffer_load_dwordx4 v25, s[12:15], s34 offen lds
    s_add_u32 m0, s29, 20480
    s_add_u32 s34, s28, 131840
    buffer_load_dwordx4 v24, s[12:15], s34 offen lds
    s_add_u32 m0, s29, 21504
    s_add_u32 s34, s28, 164608
    buffer_load_dwordx4 v25, s[12:15], s34 offen lds
    s_add_u32 m0, s29, 22528
    s_add_u32 s34, s28, 197376
    buffer_load_dwordx4 v24, s[12:15], s34 offen lds
    s_add_u32 m0, s29, 23552
    s_add_u32 s34, s28, 230144
    buffer_load_dwordx4 v25, s[12:15], s34 offen lds
    buffer_load_dwordx4 v[96:99], v4, s[20:23], s27 offen offset:0
    buffer_load_dwordx4 v[100:103], v4, s[20:23], s27 offen offset:1024
    buffer_load_dwordx4 v[104:107], v4, s[20:23], s27 offen offset:2048
    buffer_load_dwordx4 v[108:111], v4, s[20:23], s27 offen offset:3072
    buffer_load_dwordx4 v[112:115], v5, s[20:23], s27 offen offset:0
    buffer_load_dwordx4 v[116:119], v5, s[20:23], s27 offen offset:1024
    s_add_u32 s27, s27, 6144
    s_waitcnt vmcnt(20)
    v_mfma_f32_16x16x32_bf16 v[144:147], v[16:19], v[56:59], v[144:147]
    v_mfma_f32_16x16x32_bf16 v[148:151], v[16:19], v[60:63], v[148:151]
    v_mfma_f32_16x16x32_bf16 v[152:155], v[16:19], v[64:67], v[152:155]
    v_mfma_f32_16x16x32_bf16 v[156:159], v[16:19], v[68:71], v[156:159]
    ds_read_b128 v[16:19], v7 offset:2432
    v_mfma_f32_16x16x32_bf16 v[160:163], v[120:123], v[56:59], v[160:163]
    v_mfma_f32_16x16x32_bf16 v[164:167], v[120:123], v[60:63], v[164:167]
    v_mfma_f32_16x16x32_bf16 v[168:171], v[120:123], v[64:67], v[168:171]
    v_mfma_f32_16x16x32_bf16 v[172:175], v[120:123], v[68:71], v[172:175]
    s_waitcnt lgkmcnt(1)
    v_mfma_f32_16x16x32_bf16 v[176:179], v[124:127], v[56:59], v[176:179]
    v_lshlrev_b32 v20, 16, v40
    v_and_b32 v21, s35, v40
    v_mul_f32 v20, v20, v8
    v_mul_f32 v21, v21, v9
    v_mfma_f32_16x16x32_bf16 v[180:183], v[124:127], v[60:63], v[180:183]
    v_cvt_pk_bf16_f32 v40, v20, v21
    v_lshlrev_b32 v22, 16, v41
    v_and_b32 v23, s35, v41
    v_mul_f32 v22, v22, v10
    v_mfma_f32_16x16x32_bf16 v[184:187], v[124:127], v[64:67], v[184:187]
    v_mul_f32 v23, v23, v11
    v_cvt_pk_bf16_f32 v41, v22, v23
    v_lshlrev_b32 v20, 16, v42
    v_and_b32 v21, s35, v42
    v_mfma_f32_16x16x32_bf16 v[188:191], v[124:127], v[68:71], v[188:191]
    v_mul_f32 v20, v20, v12
    v_mul_f32 v21, v21, v13
    v_cvt_pk_bf16_f32 v42, v20, v21
    v_lshlrev_b32 v22, 16, v43
    v_mfma_f32_16x16x32_bf16 v[192:195], v[128:131], v[56:59], v[192:195]
    v_and_b32 v23, s35, v43
    v_mul_f32 v22, v22, v14
    v_mul_f32 v23, v23, v15
    v_cvt_pk_bf16_f32 v43, v22, v23
    v_mfma_f32_16x16x32_bf16 v[196:199], v[128:131], v[60:63], v[196:199]
    v_lshlrev_b32 v20, 16, v44
    v_and_b32 v21, s35, v44
    v_mul_f32 v20, v20, v8
    v_mul_f32 v21, v21, v9
    v_mfma_f32_16x16x32_bf16 v[200:203], v[128:131], v[64:67], v[200:203]
    v_cvt_pk_bf16_f32 v44, v20, v21
    v_lshlrev_b32 v22, 16, v45
    v_and_b32 v23, s35, v45
    v_mul_f32 v22, v22, v10
    v_mfma_f32_16x16x32_bf16 v[204:207], v[128:131], v[68:71], v[204:207]
    v_mul_f32 v23, v23, v11
    v_cvt_pk_bf16_f32 v45, v22, v23
    v_lshlrev_b32 v20, 16, v46
    v_and_b32 v21, s35, v46
    v_mfma_f32_16x16x32_bf16 v[208:211], v[132:135], v[56:59], v[208:211]
    v_mul_f32 v20, v20, v12
    v_mul_f32 v21, v21, v13
    v_cvt_pk_bf16_f32 v46, v20, v21
    v_lshlrev_b32 v22, 16, v47
    v_mfma_f32_16x16x32_bf16 v[212:215], v[132:135], v[60:63], v[212:215]
    v_and_b32 v23, s35, v47
    v_mul_f32 v22, v22, v14
    v_mul_f32 v23, v23, v15
    v_cvt_pk_bf16_f32 v47, v22, v23
    v_mfma_f32_16x16x32_bf16 v[216:219], v[132:135], v[64:67], v[216:219]
    v_lshlrev_b32 v20, 16, v48
    v_and_b32 v21, s35, v48
    v_mul_f32 v20, v20, v8
    v_mul_f32 v21, v21, v9
    v_mfma_f32_16x16x32_bf16 v[220:223], v[132:135], v[68:71], v[220:223]
    v_cvt_pk_bf16_f32 v48, v20, v21
    v_lshlrev_b32 v22, 16, v49
    v_and_b32 v23, s35, v49
    v_mul_f32 v22, v22, v10
    v_mfma_f32_16x16x32_bf16 v[224:227], v[136:139], v[56:59], v[224:227]
    v_mul_f32 v23, v23, v11
    v_cvt_pk_bf16_f32 v49, v22, v23
    v_lshlrev_b32 v20, 16, v50
    v_and_b32 v21, s35, v50
    v_mfma_f32_16x16x32_bf16 v[228:231], v[136:139], v[60:63], v[228:231]
    v_mul_f32 v20, v20, v12
    v_mul_f32 v21, v21, v13
    v_cvt_pk_bf16_f32 v50, v20, v21
    v_lshlrev_b32 v22, 16, v51
    v_mfma_f32_16x16x32_bf16 v[232:235], v[136:139], v[64:67], v[232:235]
    v_and_b32 v23, s35, v51
    v_mul_f32 v22, v22, v14
    v_mul_f32 v23, v23, v15
    v_cvt_pk_bf16_f32 v51, v22, v23
    v_mfma_f32_16x16x32_bf16 v[236:239], v[136:139], v[68:71], v[236:239]
    v_lshlrev_b32 v20, 16, v52
    v_and_b32 v21, s35, v52
    v_mul_f32 v20, v20, v8
    v_mul_f32 v21, v21, v9
    v_mfma_f32_16x16x32_bf16 v[240:243], v[140:143], v[56:59], v[240:243]
    v_cvt_pk_bf16_f32 v52, v20, v21
    v_lshlrev_b32 v22, 16, v53
    v_and_b32 v23, s35, v53
    v_mul_f32 v22, v22, v10
    v_mfma_f32_16x16x32_bf16 v[244:247], v[140:143], v[60:63], v[244:247]
    v_mul_f32 v23, v23, v11
    v_cvt_pk_bf16_f32 v53, v22, v23
    v_lshlrev_b32 v20, 16, v54
    v_and_b32 v21, s35, v54
    v_mfma_f32_16x16x32_bf16 v[248:251], v[140:143], v[64:67], v[248:251]
    v_mul_f32 v20, v20, v12
    v_mul_f32 v21, v21, v13
    v_cvt_pk_bf16_f32 v54, v20, v21
    v_lshlrev_b32 v22, 16, v55
    v_mfma_f32_16x16x32_bf16 v[252:255], v[140:143], v[68:71], v[252:255]
    v_and_b32 v23, s35, v55
    v_mul_f32 v22, v22, v14
    v_mul_f32 v23, v23, v15
    v_cvt_pk_bf16_f32 v55, v22, v23
    ds_read_b128 v[8:11], v6 offset:896
    ds_read_b128 v[12:15], v6 offset:912
    ds_read_b128 v[56:59], v27 offset:24576
    ds_read_b128 v[60:63], v27 offset:26624
    ds_read_b128 v[64:67], v27 offset:28672
    ds_read_b128 v[68:71], v27 offset:30720
    s_waitcnt lgkmcnt(6)
    buffer_load_dwordx4 v[120:123], v4, s[20:23], s27 offen offset:0
    buffer_load_dwordx4 v[124:127], v4, s[20:23], s27 offen offset:1024
    buffer_load_dwordx4 v[128:131], v4, s[20:23], s27 offen offset:2048
    buffer_load_dwordx4 v[132:135], v4, s[20:23], s27 offen offset:3072
    buffer_load_dwordx4 v[136:139], v5, s[20:23], s27 offen offset:0
    buffer_load_dwordx4 v[140:143], v5, s[20:23], s27 offen offset:1024
    s_add_u32 s27, s27, 6144
    s_waitcnt vmcnt(20)
    v_mfma_f32_16x16x32_bf16 v[144:147], v[16:19], v[40:43], v[144:147]
    v_mfma_f32_16x16x32_bf16 v[148:151], v[16:19], v[44:47], v[148:151]
    v_mfma_f32_16x16x32_bf16 v[152:155], v[16:19], v[48:51], v[152:155]
    v_mfma_f32_16x16x32_bf16 v[156:159], v[16:19], v[52:55], v[156:159]
    ds_read_b128 v[16:19], v7 offset:2496
    v_mfma_f32_16x16x32_bf16 v[160:163], v[72:75], v[40:43], v[160:163]
    v_mfma_f32_16x16x32_bf16 v[164:167], v[72:75], v[44:47], v[164:167]
    v_mfma_f32_16x16x32_bf16 v[168:171], v[72:75], v[48:51], v[168:171]
    v_mfma_f32_16x16x32_bf16 v[172:175], v[72:75], v[52:55], v[172:175]
    s_waitcnt lgkmcnt(1)
    v_mfma_f32_16x16x32_bf16 v[176:179], v[76:79], v[40:43], v[176:179]
    v_lshlrev_b32 v20, 16, v56
    v_and_b32 v21, s35, v56
    v_mul_f32 v20, v20, v8
    v_mul_f32 v21, v21, v9
    v_mfma_f32_16x16x32_bf16 v[180:183], v[76:79], v[44:47], v[180:183]
    v_cvt_pk_bf16_f32 v56, v20, v21
    v_lshlrev_b32 v22, 16, v57
    v_and_b32 v23, s35, v57
    v_mul_f32 v22, v22, v10
    v_mfma_f32_16x16x32_bf16 v[184:187], v[76:79], v[48:51], v[184:187]
    v_mul_f32 v23, v23, v11
    v_cvt_pk_bf16_f32 v57, v22, v23
    v_lshlrev_b32 v20, 16, v58
    v_and_b32 v21, s35, v58
    v_mfma_f32_16x16x32_bf16 v[188:191], v[76:79], v[52:55], v[188:191]
    v_mul_f32 v20, v20, v12
    v_mul_f32 v21, v21, v13
    v_cvt_pk_bf16_f32 v58, v20, v21
    v_lshlrev_b32 v22, 16, v59
    v_mfma_f32_16x16x32_bf16 v[192:195], v[80:83], v[40:43], v[192:195]
    v_and_b32 v23, s35, v59
    v_mul_f32 v22, v22, v14
    v_mul_f32 v23, v23, v15
    v_cvt_pk_bf16_f32 v59, v22, v23
    v_mfma_f32_16x16x32_bf16 v[196:199], v[80:83], v[44:47], v[196:199]
    v_lshlrev_b32 v20, 16, v60
    v_and_b32 v21, s35, v60
    v_mul_f32 v20, v20, v8
    v_mul_f32 v21, v21, v9
    v_mfma_f32_16x16x32_bf16 v[200:203], v[80:83], v[48:51], v[200:203]
    v_cvt_pk_bf16_f32 v60, v20, v21
    v_lshlrev_b32 v22, 16, v61
    v_and_b32 v23, s35, v61
    v_mul_f32 v22, v22, v10
    v_mfma_f32_16x16x32_bf16 v[204:207], v[80:83], v[52:55], v[204:207]
    v_mul_f32 v23, v23, v11
    v_cvt_pk_bf16_f32 v61, v22, v23
    v_lshlrev_b32 v20, 16, v62
    v_and_b32 v21, s35, v62
    v_mfma_f32_16x16x32_bf16 v[208:211], v[84:87], v[40:43], v[208:211]
    v_mul_f32 v20, v20, v12
    v_mul_f32 v21, v21, v13
    v_cvt_pk_bf16_f32 v62, v20, v21
    v_lshlrev_b32 v22, 16, v63
    v_mfma_f32_16x16x32_bf16 v[212:215], v[84:87], v[44:47], v[212:215]
    v_and_b32 v23, s35, v63
    v_mul_f32 v22, v22, v14
    v_mul_f32 v23, v23, v15
    v_cvt_pk_bf16_f32 v63, v22, v23
    v_mfma_f32_16x16x32_bf16 v[216:219], v[84:87], v[48:51], v[216:219]
    v_lshlrev_b32 v20, 16, v64
    v_and_b32 v21, s35, v64
    v_mul_f32 v20, v20, v8
    v_mul_f32 v21, v21, v9
    v_mfma_f32_16x16x32_bf16 v[220:223], v[84:87], v[52:55], v[220:223]
    v_cvt_pk_bf16_f32 v64, v20, v21
    v_lshlrev_b32 v22, 16, v65
    v_and_b32 v23, s35, v65
    v_mul_f32 v22, v22, v10
    v_mfma_f32_16x16x32_bf16 v[224:227], v[88:91], v[40:43], v[224:227]
    v_mul_f32 v23, v23, v11
    v_cvt_pk_bf16_f32 v65, v22, v23
    v_lshlrev_b32 v20, 16, v66
    v_and_b32 v21, s35, v66
    v_mfma_f32_16x16x32_bf16 v[228:231], v[88:91], v[44:47], v[228:231]
    v_mul_f32 v20, v20, v12
    v_mul_f32 v21, v21, v13
    v_cvt_pk_bf16_f32 v66, v20, v21
    v_lshlrev_b32 v22, 16, v67
    v_mfma_f32_16x16x32_bf16 v[232:235], v[88:91], v[48:51], v[232:235]
    v_and_b32 v23, s35, v67
    v_mul_f32 v22, v22, v14
    v_mul_f32 v23, v23, v15
    v_cvt_pk_bf16_f32 v67, v22, v23
    v_mfma_f32_16x16x32_bf16 v[236:239], v[88:91], v[52:55], v[236:239]
    v_lshlrev_b32 v20, 16, v68
    v_and_b32 v21, s35, v68
    v_mul_f32 v20, v20, v8
    v_mul_f32 v21, v21, v9
    v_mfma_f32_16x16x32_bf16 v[240:243], v[92:95], v[40:43], v[240:243]
    v_cvt_pk_bf16_f32 v68, v20, v21
    v_lshlrev_b32 v22, 16, v69
    v_and_b32 v23, s35, v69
    v_mul_f32 v22, v22, v10
    v_mfma_f32_16x16x32_bf16 v[244:247], v[92:95], v[44:47], v[244:247]
    v_mul_f32 v23, v23, v11
    v_cvt_pk_bf16_f32 v69, v22, v23
    v_lshlrev_b32 v20, 16, v70
    v_and_b32 v21, s35, v70
    v_mfma_f32_16x16x32_bf16 v[248:251], v[92:95], v[48:51], v[248:251]
    v_mul_f32 v20, v20, v12
    v_mul_f32 v21, v21, v13
    v_cvt_pk_bf16_f32 v70, v20, v21
    v_lshlrev_b32 v22, 16, v71
    v_mfma_f32_16x16x32_bf16 v[252:255], v[92:95], v[52:55], v[252:255]
    v_and_b32 v23, s35, v71
    v_mul_f32 v22, v22, v14
    v_mul_f32 v23, v23, v15
    v_cvt_pk_bf16_f32 v71, v22, v23
    ds_read_b128 v[8:11], v6 offset:1024
    ds_read_b128 v[12:15], v6 offset:1040
    s_waitcnt vmcnt(52)
    ds_read_b128 v[40:43], v26 offset:0
    ds_read_b128 v[44:47], v26 offset:2048
    ds_read_b128 v[48:51], v26 offset:4096
    ds_read_b128 v[52:55], v26 offset:6144
    s_waitcnt lgkmcnt(6)
    s_add_u32 m0, s29, 24576
    s_add_u32 s34, s28, 896
    buffer_load_dwordx4 v24, s[12:15], s34 offen lds
    s_add_u32 m0, s29, 25600
    s_add_u32 s34, s28, 33664
    buffer_load_dwordx4 v25, s[12:15], s34 offen lds
    s_add_u32 m0, s29, 26624
    s_add_u32 s34, s28, 66432
    buffer_load_dwordx4 v24, s[12:15], s34 offen lds
    s_add_u32 m0, s29, 27648
    s_add_u32 s34, s28, 99200
    buffer_load_dwordx4 v25, s[12:15], s34 offen lds
    s_add_u32 m0, s29, 28672
    s_add_u32 s34, s28, 131968
    buffer_load_dwordx4 v24, s[12:15], s34 offen lds
    s_add_u32 m0, s29, 29696
    s_add_u32 s34, s28, 164736
    buffer_load_dwordx4 v25, s[12:15], s34 offen lds
    s_add_u32 m0, s29, 30720
    s_add_u32 s34, s28, 197504
    buffer_load_dwordx4 v24, s[12:15], s34 offen lds
    s_add_u32 m0, s29, 31744
    s_add_u32 s34, s28, 230272
    buffer_load_dwordx4 v25, s[12:15], s34 offen lds
    buffer_load_dwordx4 v[72:75], v4, s[20:23], s27 offen offset:0
    buffer_load_dwordx4 v[76:79], v4, s[20:23], s27 offen offset:1024
    buffer_load_dwordx4 v[80:83], v4, s[20:23], s27 offen offset:2048
    buffer_load_dwordx4 v[84:87], v4, s[20:23], s27 offen offset:3072
    buffer_load_dwordx4 v[88:91], v5, s[20:23], s27 offen offset:0
    buffer_load_dwordx4 v[92:95], v5, s[20:23], s27 offen offset:1024
    s_add_u32 s27, s27, 6144
    s_waitcnt vmcnt(20)
    v_mfma_f32_16x16x32_bf16 v[144:147], v[16:19], v[56:59], v[144:147]
    v_mfma_f32_16x16x32_bf16 v[148:151], v[16:19], v[60:63], v[148:151]
    v_mfma_f32_16x16x32_bf16 v[152:155], v[16:19], v[64:67], v[152:155]
    v_mfma_f32_16x16x32_bf16 v[156:159], v[16:19], v[68:71], v[156:159]
    ds_read_b128 v[16:19], v7 offset:2560
    v_mfma_f32_16x16x32_bf16 v[160:163], v[96:99], v[56:59], v[160:163]
    v_mfma_f32_16x16x32_bf16 v[164:167], v[96:99], v[60:63], v[164:167]
    v_mfma_f32_16x16x32_bf16 v[168:171], v[96:99], v[64:67], v[168:171]
    v_mfma_f32_16x16x32_bf16 v[172:175], v[96:99], v[68:71], v[172:175]
    s_waitcnt lgkmcnt(1)
    v_mfma_f32_16x16x32_bf16 v[176:179], v[100:103], v[56:59], v[176:179]
    v_lshlrev_b32 v20, 16, v40
    v_and_b32 v21, s35, v40
    v_mul_f32 v20, v20, v8
    v_mul_f32 v21, v21, v9
    v_mfma_f32_16x16x32_bf16 v[180:183], v[100:103], v[60:63], v[180:183]
    v_cvt_pk_bf16_f32 v40, v20, v21
    v_lshlrev_b32 v22, 16, v41
    v_and_b32 v23, s35, v41
    v_mul_f32 v22, v22, v10
    v_mfma_f32_16x16x32_bf16 v[184:187], v[100:103], v[64:67], v[184:187]
    v_mul_f32 v23, v23, v11
    v_cvt_pk_bf16_f32 v41, v22, v23
    v_lshlrev_b32 v20, 16, v42
    v_and_b32 v21, s35, v42
    v_mfma_f32_16x16x32_bf16 v[188:191], v[100:103], v[68:71], v[188:191]
    v_mul_f32 v20, v20, v12
    v_mul_f32 v21, v21, v13
    v_cvt_pk_bf16_f32 v42, v20, v21
    v_lshlrev_b32 v22, 16, v43
    v_mfma_f32_16x16x32_bf16 v[192:195], v[104:107], v[56:59], v[192:195]
    v_and_b32 v23, s35, v43
    v_mul_f32 v22, v22, v14
    v_mul_f32 v23, v23, v15
    v_cvt_pk_bf16_f32 v43, v22, v23
    v_mfma_f32_16x16x32_bf16 v[196:199], v[104:107], v[60:63], v[196:199]
    v_lshlrev_b32 v20, 16, v44
    v_and_b32 v21, s35, v44
    v_mul_f32 v20, v20, v8
    v_mul_f32 v21, v21, v9
    v_mfma_f32_16x16x32_bf16 v[200:203], v[104:107], v[64:67], v[200:203]
    v_cvt_pk_bf16_f32 v44, v20, v21
    v_lshlrev_b32 v22, 16, v45
    v_and_b32 v23, s35, v45
    v_mul_f32 v22, v22, v10
    v_mfma_f32_16x16x32_bf16 v[204:207], v[104:107], v[68:71], v[204:207]
    v_mul_f32 v23, v23, v11
    v_cvt_pk_bf16_f32 v45, v22, v23
    v_lshlrev_b32 v20, 16, v46
    v_and_b32 v21, s35, v46
    v_mfma_f32_16x16x32_bf16 v[208:211], v[108:111], v[56:59], v[208:211]
    v_mul_f32 v20, v20, v12
    v_mul_f32 v21, v21, v13
    v_cvt_pk_bf16_f32 v46, v20, v21
    v_lshlrev_b32 v22, 16, v47
    v_mfma_f32_16x16x32_bf16 v[212:215], v[108:111], v[60:63], v[212:215]
    v_and_b32 v23, s35, v47
    v_mul_f32 v22, v22, v14
    v_mul_f32 v23, v23, v15
    v_cvt_pk_bf16_f32 v47, v22, v23
    v_mfma_f32_16x16x32_bf16 v[216:219], v[108:111], v[64:67], v[216:219]
    v_lshlrev_b32 v20, 16, v48
    v_and_b32 v21, s35, v48
    v_mul_f32 v20, v20, v8
    v_mul_f32 v21, v21, v9
    v_mfma_f32_16x16x32_bf16 v[220:223], v[108:111], v[68:71], v[220:223]
    v_cvt_pk_bf16_f32 v48, v20, v21
    v_lshlrev_b32 v22, 16, v49
    v_and_b32 v23, s35, v49
    v_mul_f32 v22, v22, v10
    v_mfma_f32_16x16x32_bf16 v[224:227], v[112:115], v[56:59], v[224:227]
    v_mul_f32 v23, v23, v11
    v_cvt_pk_bf16_f32 v49, v22, v23
    v_lshlrev_b32 v20, 16, v50
    v_and_b32 v21, s35, v50
    v_mfma_f32_16x16x32_bf16 v[228:231], v[112:115], v[60:63], v[228:231]
    v_mul_f32 v20, v20, v12
    v_mul_f32 v21, v21, v13
    v_cvt_pk_bf16_f32 v50, v20, v21
    v_lshlrev_b32 v22, 16, v51
    v_mfma_f32_16x16x32_bf16 v[232:235], v[112:115], v[64:67], v[232:235]
    v_and_b32 v23, s35, v51
    v_mul_f32 v22, v22, v14
    v_mul_f32 v23, v23, v15
    v_cvt_pk_bf16_f32 v51, v22, v23
    v_mfma_f32_16x16x32_bf16 v[236:239], v[112:115], v[68:71], v[236:239]
    v_lshlrev_b32 v20, 16, v52
    v_and_b32 v21, s35, v52
    v_mul_f32 v20, v20, v8
    v_mul_f32 v21, v21, v9
    v_mfma_f32_16x16x32_bf16 v[240:243], v[116:119], v[56:59], v[240:243]
    v_cvt_pk_bf16_f32 v52, v20, v21
    v_lshlrev_b32 v22, 16, v53
    v_and_b32 v23, s35, v53
    v_mul_f32 v22, v22, v10
    v_mfma_f32_16x16x32_bf16 v[244:247], v[116:119], v[60:63], v[244:247]
    v_mul_f32 v23, v23, v11
    v_cvt_pk_bf16_f32 v53, v22, v23
    v_lshlrev_b32 v20, 16, v54
    v_and_b32 v21, s35, v54
    v_mfma_f32_16x16x32_bf16 v[248:251], v[116:119], v[64:67], v[248:251]
    v_mul_f32 v20, v20, v12
    v_mul_f32 v21, v21, v13
    v_cvt_pk_bf16_f32 v54, v20, v21
    v_lshlrev_b32 v22, 16, v55
    v_mfma_f32_16x16x32_bf16 v[252:255], v[116:119], v[68:71], v[252:255]
    v_and_b32 v23, s35, v55
    v_mul_f32 v22, v22, v14
    v_mul_f32 v23, v23, v15
    v_cvt_pk_bf16_f32 v55, v22, v23
    ds_read_b128 v[8:11], v6 offset:1152
    ds_read_b128 v[12:15], v6 offset:1168
    ds_read_b128 v[56:59], v27 offset:0
    ds_read_b128 v[60:63], v27 offset:2048
    ds_read_b128 v[64:67], v27 offset:4096
    ds_read_b128 v[68:71], v27 offset:6144
    s_waitcnt lgkmcnt(6)
    buffer_load_dwordx4 v[96:99], v4, s[20:23], s27 offen offset:0
    buffer_load_dwordx4 v[100:103], v4, s[20:23], s27 offen offset:1024
    buffer_load_dwordx4 v[104:107], v4, s[20:23], s27 offen offset:2048
    buffer_load_dwordx4 v[108:111], v4, s[20:23], s27 offen offset:3072
    buffer_load_dwordx4 v[112:115], v5, s[20:23], s27 offen offset:0
    buffer_load_dwordx4 v[116:119], v5, s[20:23], s27 offen offset:1024
    s_add_u32 s27, s27, 6144
    s_waitcnt vmcnt(20)
    v_mfma_f32_16x16x32_bf16 v[144:147], v[16:19], v[40:43], v[144:147]
    v_mfma_f32_16x16x32_bf16 v[148:151], v[16:19], v[44:47], v[148:151]
    v_mfma_f32_16x16x32_bf16 v[152:155], v[16:19], v[48:51], v[152:155]
    v_mfma_f32_16x16x32_bf16 v[156:159], v[16:19], v[52:55], v[156:159]
    ds_read_b128 v[16:19], v7 offset:2624
    v_mfma_f32_16x16x32_bf16 v[160:163], v[120:123], v[40:43], v[160:163]
    v_mfma_f32_16x16x32_bf16 v[164:167], v[120:123], v[44:47], v[164:167]
    v_mfma_f32_16x16x32_bf16 v[168:171], v[120:123], v[48:51], v[168:171]
    v_mfma_f32_16x16x32_bf16 v[172:175], v[120:123], v[52:55], v[172:175]
    s_waitcnt lgkmcnt(1)
    v_mfma_f32_16x16x32_bf16 v[176:179], v[124:127], v[40:43], v[176:179]
    v_lshlrev_b32 v20, 16, v56
    v_and_b32 v21, s35, v56
    v_mul_f32 v20, v20, v8
    v_mul_f32 v21, v21, v9
    v_mfma_f32_16x16x32_bf16 v[180:183], v[124:127], v[44:47], v[180:183]
    v_cvt_pk_bf16_f32 v56, v20, v21
    v_lshlrev_b32 v22, 16, v57
    v_and_b32 v23, s35, v57
    v_mul_f32 v22, v22, v10
    v_mfma_f32_16x16x32_bf16 v[184:187], v[124:127], v[48:51], v[184:187]
    v_mul_f32 v23, v23, v11
    v_cvt_pk_bf16_f32 v57, v22, v23
    v_lshlrev_b32 v20, 16, v58
    v_and_b32 v21, s35, v58
    v_mfma_f32_16x16x32_bf16 v[188:191], v[124:127], v[52:55], v[188:191]
    v_mul_f32 v20, v20, v12
    v_mul_f32 v21, v21, v13
    v_cvt_pk_bf16_f32 v58, v20, v21
    v_lshlrev_b32 v22, 16, v59
    v_mfma_f32_16x16x32_bf16 v[192:195], v[128:131], v[40:43], v[192:195]
    v_and_b32 v23, s35, v59
    v_mul_f32 v22, v22, v14
    v_mul_f32 v23, v23, v15
    v_cvt_pk_bf16_f32 v59, v22, v23
    v_mfma_f32_16x16x32_bf16 v[196:199], v[128:131], v[44:47], v[196:199]
    v_lshlrev_b32 v20, 16, v60
    v_and_b32 v21, s35, v60
    v_mul_f32 v20, v20, v8
    v_mul_f32 v21, v21, v9
    v_mfma_f32_16x16x32_bf16 v[200:203], v[128:131], v[48:51], v[200:203]
    v_cvt_pk_bf16_f32 v60, v20, v21
    v_lshlrev_b32 v22, 16, v61
    v_and_b32 v23, s35, v61
    v_mul_f32 v22, v22, v10
    v_mfma_f32_16x16x32_bf16 v[204:207], v[128:131], v[52:55], v[204:207]
    v_mul_f32 v23, v23, v11
    v_cvt_pk_bf16_f32 v61, v22, v23
    v_lshlrev_b32 v20, 16, v62
    v_and_b32 v21, s35, v62
    v_mfma_f32_16x16x32_bf16 v[208:211], v[132:135], v[40:43], v[208:211]
    v_mul_f32 v20, v20, v12
    v_mul_f32 v21, v21, v13
    v_cvt_pk_bf16_f32 v62, v20, v21
    v_lshlrev_b32 v22, 16, v63
    v_mfma_f32_16x16x32_bf16 v[212:215], v[132:135], v[44:47], v[212:215]
    v_and_b32 v23, s35, v63
    v_mul_f32 v22, v22, v14
    v_mul_f32 v23, v23, v15
    v_cvt_pk_bf16_f32 v63, v22, v23
    v_mfma_f32_16x16x32_bf16 v[216:219], v[132:135], v[48:51], v[216:219]
    v_lshlrev_b32 v20, 16, v64
    v_and_b32 v21, s35, v64
    v_mul_f32 v20, v20, v8
    v_mul_f32 v21, v21, v9
    v_mfma_f32_16x16x32_bf16 v[220:223], v[132:135], v[52:55], v[220:223]
    v_cvt_pk_bf16_f32 v64, v20, v21
    v_lshlrev_b32 v22, 16, v65
    v_and_b32 v23, s35, v65
    v_mul_f32 v22, v22, v10
    v_mfma_f32_16x16x32_bf16 v[224:227], v[136:139], v[40:43], v[224:227]
    v_mul_f32 v23, v23, v11
    v_cvt_pk_bf16_f32 v65, v22, v23
    v_lshlrev_b32 v20, 16, v66
    v_and_b32 v21, s35, v66
    v_mfma_f32_16x16x32_bf16 v[228:231], v[136:139], v[44:47], v[228:231]
    v_mul_f32 v20, v20, v12
    v_mul_f32 v21, v21, v13
    v_cvt_pk_bf16_f32 v66, v20, v21
    v_lshlrev_b32 v22, 16, v67
    v_mfma_f32_16x16x32_bf16 v[232:235], v[136:139], v[48:51], v[232:235]
    v_and_b32 v23, s35, v67
    v_mul_f32 v22, v22, v14
    v_mul_f32 v23, v23, v15
    v_cvt_pk_bf16_f32 v67, v22, v23
    v_mfma_f32_16x16x32_bf16 v[236:239], v[136:139], v[52:55], v[236:239]
    v_lshlrev_b32 v20, 16, v68
    v_and_b32 v21, s35, v68
    v_mul_f32 v20, v20, v8
    v_mul_f32 v21, v21, v9
    v_mfma_f32_16x16x32_bf16 v[240:243], v[140:143], v[40:43], v[240:243]
    v_cvt_pk_bf16_f32 v68, v20, v21
    v_lshlrev_b32 v22, 16, v69
    v_and_b32 v23, s35, v69
    v_mul_f32 v22, v22, v10
    v_mfma_f32_16x16x32_bf16 v[244:247], v[140:143], v[44:47], v[244:247]
    v_mul_f32 v23, v23, v11
    v_cvt_pk_bf16_f32 v69, v22, v23
    v_lshlrev_b32 v20, 16, v70
    v_and_b32 v21, s35, v70
    v_mfma_f32_16x16x32_bf16 v[248:251], v[140:143], v[48:51], v[248:251]
    v_mul_f32 v20, v20, v12
    v_mul_f32 v21, v21, v13
    v_cvt_pk_bf16_f32 v70, v20, v21
    v_lshlrev_b32 v22, 16, v71
    v_mfma_f32_16x16x32_bf16 v[252:255], v[140:143], v[52:55], v[252:255]
    v_and_b32 v23, s35, v71
    v_mul_f32 v22, v22, v14
    v_mul_f32 v23, v23, v15
    v_cvt_pk_bf16_f32 v71, v22, v23
    ds_read_b128 v[8:11], v6 offset:1280
    ds_read_b128 v[12:15], v6 offset:1296
    s_waitcnt vmcnt(52)
    ds_read_b128 v[40:43], v26 offset:8192
    ds_read_b128 v[44:47], v26 offset:10240
    ds_read_b128 v[48:51], v26 offset:12288
    ds_read_b128 v[52:55], v26 offset:14336
    s_waitcnt lgkmcnt(6)
    buffer_load_dwordx4 v[120:123], v4, s[20:23], s27 offen offset:0
    buffer_load_dwordx4 v[124:127], v4, s[20:23], s27 offen offset:1024
    buffer_load_dwordx4 v[128:131], v4, s[20:23], s27 offen offset:2048
    buffer_load_dwordx4 v[132:135], v4, s[20:23], s27 offen offset:3072
    buffer_load_dwordx4 v[136:139], v5, s[20:23], s27 offen offset:0
    buffer_load_dwordx4 v[140:143], v5, s[20:23], s27 offen offset:1024
    s_add_u32 s27, s27, 6144
    s_waitcnt vmcnt(12)
    v_mfma_f32_16x16x32_bf16 v[144:147], v[16:19], v[56:59], v[144:147]
    v_mfma_f32_16x16x32_bf16 v[148:151], v[16:19], v[60:63], v[148:151]
    v_mfma_f32_16x16x32_bf16 v[152:155], v[16:19], v[64:67], v[152:155]
    v_mfma_f32_16x16x32_bf16 v[156:159], v[16:19], v[68:71], v[156:159]
    ds_read_b128 v[16:19], v7 offset:2688
    v_mfma_f32_16x16x32_bf16 v[160:163], v[72:75], v[56:59], v[160:163]
    v_mfma_f32_16x16x32_bf16 v[164:167], v[72:75], v[60:63], v[164:167]
    v_mfma_f32_16x16x32_bf16 v[168:171], v[72:75], v[64:67], v[168:171]
    v_mfma_f32_16x16x32_bf16 v[172:175], v[72:75], v[68:71], v[172:175]
    s_waitcnt lgkmcnt(1)
    v_mfma_f32_16x16x32_bf16 v[176:179], v[76:79], v[56:59], v[176:179]
    v_lshlrev_b32 v20, 16, v40
    v_and_b32 v21, s35, v40
    v_mul_f32 v20, v20, v8
    v_mul_f32 v21, v21, v9
    v_mfma_f32_16x16x32_bf16 v[180:183], v[76:79], v[60:63], v[180:183]
    v_cvt_pk_bf16_f32 v40, v20, v21
    v_lshlrev_b32 v22, 16, v41
    v_and_b32 v23, s35, v41
    v_mul_f32 v22, v22, v10
    v_mfma_f32_16x16x32_bf16 v[184:187], v[76:79], v[64:67], v[184:187]
    v_mul_f32 v23, v23, v11
    v_cvt_pk_bf16_f32 v41, v22, v23
    v_lshlrev_b32 v20, 16, v42
    v_and_b32 v21, s35, v42
    v_mfma_f32_16x16x32_bf16 v[188:191], v[76:79], v[68:71], v[188:191]
    v_mul_f32 v20, v20, v12
    v_mul_f32 v21, v21, v13
    v_cvt_pk_bf16_f32 v42, v20, v21
    v_lshlrev_b32 v22, 16, v43
    v_mfma_f32_16x16x32_bf16 v[192:195], v[80:83], v[56:59], v[192:195]
    v_and_b32 v23, s35, v43
    v_mul_f32 v22, v22, v14
    v_mul_f32 v23, v23, v15
    v_cvt_pk_bf16_f32 v43, v22, v23
    v_mfma_f32_16x16x32_bf16 v[196:199], v[80:83], v[60:63], v[196:199]
    v_lshlrev_b32 v20, 16, v44
    v_and_b32 v21, s35, v44
    v_mul_f32 v20, v20, v8
    v_mul_f32 v21, v21, v9
    v_mfma_f32_16x16x32_bf16 v[200:203], v[80:83], v[64:67], v[200:203]
    v_cvt_pk_bf16_f32 v44, v20, v21
    v_lshlrev_b32 v22, 16, v45
    v_and_b32 v23, s35, v45
    v_mul_f32 v22, v22, v10
    v_mfma_f32_16x16x32_bf16 v[204:207], v[80:83], v[68:71], v[204:207]
    v_mul_f32 v23, v23, v11
    v_cvt_pk_bf16_f32 v45, v22, v23
    v_lshlrev_b32 v20, 16, v46
    v_and_b32 v21, s35, v46
    v_mfma_f32_16x16x32_bf16 v[208:211], v[84:87], v[56:59], v[208:211]
    v_mul_f32 v20, v20, v12
    v_mul_f32 v21, v21, v13
    v_cvt_pk_bf16_f32 v46, v20, v21
    v_lshlrev_b32 v22, 16, v47
    v_mfma_f32_16x16x32_bf16 v[212:215], v[84:87], v[60:63], v[212:215]
    v_and_b32 v23, s35, v47
    v_mul_f32 v22, v22, v14
    v_mul_f32 v23, v23, v15
    v_cvt_pk_bf16_f32 v47, v22, v23
    v_mfma_f32_16x16x32_bf16 v[216:219], v[84:87], v[64:67], v[216:219]
    v_lshlrev_b32 v20, 16, v48
    v_and_b32 v21, s35, v48
    v_mul_f32 v20, v20, v8
    v_mul_f32 v21, v21, v9
    v_mfma_f32_16x16x32_bf16 v[220:223], v[84:87], v[68:71], v[220:223]
    v_cvt_pk_bf16_f32 v48, v20, v21
    v_lshlrev_b32 v22, 16, v49
    v_and_b32 v23, s35, v49
    v_mul_f32 v22, v22, v10
    v_mfma_f32_16x16x32_bf16 v[224:227], v[88:91], v[56:59], v[224:227]
    v_mul_f32 v23, v23, v11
    v_cvt_pk_bf16_f32 v49, v22, v23
    v_lshlrev_b32 v20, 16, v50
    v_and_b32 v21, s35, v50
    v_mfma_f32_16x16x32_bf16 v[228:231], v[88:91], v[60:63], v[228:231]
    v_mul_f32 v20, v20, v12
    v_mul_f32 v21, v21, v13
    v_cvt_pk_bf16_f32 v50, v20, v21
    v_lshlrev_b32 v22, 16, v51
    v_mfma_f32_16x16x32_bf16 v[232:235], v[88:91], v[64:67], v[232:235]
    v_and_b32 v23, s35, v51
    v_mul_f32 v22, v22, v14
    v_mul_f32 v23, v23, v15
    v_cvt_pk_bf16_f32 v51, v22, v23
    v_mfma_f32_16x16x32_bf16 v[236:239], v[88:91], v[68:71], v[236:239]
    v_lshlrev_b32 v20, 16, v52
    v_and_b32 v21, s35, v52
    v_mul_f32 v20, v20, v8
    v_mul_f32 v21, v21, v9
    v_mfma_f32_16x16x32_bf16 v[240:243], v[92:95], v[56:59], v[240:243]
    v_cvt_pk_bf16_f32 v52, v20, v21
    v_lshlrev_b32 v22, 16, v53
    v_and_b32 v23, s35, v53
    v_mul_f32 v22, v22, v10
    v_mfma_f32_16x16x32_bf16 v[244:247], v[92:95], v[60:63], v[244:247]
    v_mul_f32 v23, v23, v11
    v_cvt_pk_bf16_f32 v53, v22, v23
    v_lshlrev_b32 v20, 16, v54
    v_and_b32 v21, s35, v54
    v_mfma_f32_16x16x32_bf16 v[248:251], v[92:95], v[64:67], v[248:251]
    v_mul_f32 v20, v20, v12
    v_mul_f32 v21, v21, v13
    v_cvt_pk_bf16_f32 v54, v20, v21
    v_lshlrev_b32 v22, 16, v55
    v_mfma_f32_16x16x32_bf16 v[252:255], v[92:95], v[68:71], v[252:255]
    v_and_b32 v23, s35, v55
    v_mul_f32 v22, v22, v14
    v_mul_f32 v23, v23, v15
    v_cvt_pk_bf16_f32 v55, v22, v23
    ds_read_b128 v[8:11], v6 offset:1408
    ds_read_b128 v[12:15], v6 offset:1424
    ds_read_b128 v[56:59], v27 offset:8192
    ds_read_b128 v[60:63], v27 offset:10240
    ds_read_b128 v[64:67], v27 offset:12288
    ds_read_b128 v[68:71], v27 offset:14336
    s_waitcnt lgkmcnt(6)
    buffer_load_dwordx4 v[72:75], v4, s[20:23], s27 offen offset:0
    buffer_load_dwordx4 v[76:79], v4, s[20:23], s27 offen offset:1024
    buffer_load_dwordx4 v[80:83], v4, s[20:23], s27 offen offset:2048
    buffer_load_dwordx4 v[84:87], v4, s[20:23], s27 offen offset:3072
    buffer_load_dwordx4 v[88:91], v5, s[20:23], s27 offen offset:0
    buffer_load_dwordx4 v[92:95], v5, s[20:23], s27 offen offset:1024
    s_add_u32 s27, s27, 6144
    s_waitcnt vmcnt(12)
    v_mfma_f32_16x16x32_bf16 v[144:147], v[16:19], v[40:43], v[144:147]
    v_mfma_f32_16x16x32_bf16 v[148:151], v[16:19], v[44:47], v[148:151]
    v_mfma_f32_16x16x32_bf16 v[152:155], v[16:19], v[48:51], v[152:155]
    v_mfma_f32_16x16x32_bf16 v[156:159], v[16:19], v[52:55], v[156:159]
    ds_read_b128 v[16:19], v7 offset:2752
    v_mfma_f32_16x16x32_bf16 v[160:163], v[96:99], v[40:43], v[160:163]
    v_mfma_f32_16x16x32_bf16 v[164:167], v[96:99], v[44:47], v[164:167]
    v_mfma_f32_16x16x32_bf16 v[168:171], v[96:99], v[48:51], v[168:171]
    v_mfma_f32_16x16x32_bf16 v[172:175], v[96:99], v[52:55], v[172:175]
    s_waitcnt lgkmcnt(1)
    v_mfma_f32_16x16x32_bf16 v[176:179], v[100:103], v[40:43], v[176:179]
    v_lshlrev_b32 v20, 16, v56
    v_and_b32 v21, s35, v56
    v_mul_f32 v20, v20, v8
    v_mul_f32 v21, v21, v9
    v_mfma_f32_16x16x32_bf16 v[180:183], v[100:103], v[44:47], v[180:183]
    v_cvt_pk_bf16_f32 v56, v20, v21
    v_lshlrev_b32 v22, 16, v57
    v_and_b32 v23, s35, v57
    v_mul_f32 v22, v22, v10
    v_mfma_f32_16x16x32_bf16 v[184:187], v[100:103], v[48:51], v[184:187]
    v_mul_f32 v23, v23, v11
    v_cvt_pk_bf16_f32 v57, v22, v23
    v_lshlrev_b32 v20, 16, v58
    v_and_b32 v21, s35, v58
    v_mfma_f32_16x16x32_bf16 v[188:191], v[100:103], v[52:55], v[188:191]
    v_mul_f32 v20, v20, v12
    v_mul_f32 v21, v21, v13
    v_cvt_pk_bf16_f32 v58, v20, v21
    v_lshlrev_b32 v22, 16, v59
    v_mfma_f32_16x16x32_bf16 v[192:195], v[104:107], v[40:43], v[192:195]
    v_and_b32 v23, s35, v59
    v_mul_f32 v22, v22, v14
    v_mul_f32 v23, v23, v15
    v_cvt_pk_bf16_f32 v59, v22, v23
    v_mfma_f32_16x16x32_bf16 v[196:199], v[104:107], v[44:47], v[196:199]
    v_lshlrev_b32 v20, 16, v60
    v_and_b32 v21, s35, v60
    v_mul_f32 v20, v20, v8
    v_mul_f32 v21, v21, v9
    v_mfma_f32_16x16x32_bf16 v[200:203], v[104:107], v[48:51], v[200:203]
    v_cvt_pk_bf16_f32 v60, v20, v21
    v_lshlrev_b32 v22, 16, v61
    v_and_b32 v23, s35, v61
    v_mul_f32 v22, v22, v10
    v_mfma_f32_16x16x32_bf16 v[204:207], v[104:107], v[52:55], v[204:207]
    v_mul_f32 v23, v23, v11
    v_cvt_pk_bf16_f32 v61, v22, v23
    v_lshlrev_b32 v20, 16, v62
    v_and_b32 v21, s35, v62
    v_mfma_f32_16x16x32_bf16 v[208:211], v[108:111], v[40:43], v[208:211]
    v_mul_f32 v20, v20, v12
    v_mul_f32 v21, v21, v13
    v_cvt_pk_bf16_f32 v62, v20, v21
    v_lshlrev_b32 v22, 16, v63
    v_mfma_f32_16x16x32_bf16 v[212:215], v[108:111], v[44:47], v[212:215]
    v_and_b32 v23, s35, v63
    v_mul_f32 v22, v22, v14
    v_mul_f32 v23, v23, v15
    v_cvt_pk_bf16_f32 v63, v22, v23
    v_mfma_f32_16x16x32_bf16 v[216:219], v[108:111], v[48:51], v[216:219]
    v_lshlrev_b32 v20, 16, v64
    v_and_b32 v21, s35, v64
    v_mul_f32 v20, v20, v8
    v_mul_f32 v21, v21, v9
    v_mfma_f32_16x16x32_bf16 v[220:223], v[108:111], v[52:55], v[220:223]
    v_cvt_pk_bf16_f32 v64, v20, v21
    v_lshlrev_b32 v22, 16, v65
    v_and_b32 v23, s35, v65
    v_mul_f32 v22, v22, v10
    v_mfma_f32_16x16x32_bf16 v[224:227], v[112:115], v[40:43], v[224:227]
    v_mul_f32 v23, v23, v11
    v_cvt_pk_bf16_f32 v65, v22, v23
    v_lshlrev_b32 v20, 16, v66
    v_and_b32 v21, s35, v66
    v_mfma_f32_16x16x32_bf16 v[228:231], v[112:115], v[44:47], v[228:231]
    v_mul_f32 v20, v20, v12
    v_mul_f32 v21, v21, v13
    v_cvt_pk_bf16_f32 v66, v20, v21
    v_lshlrev_b32 v22, 16, v67
    v_mfma_f32_16x16x32_bf16 v[232:235], v[112:115], v[48:51], v[232:235]
    v_and_b32 v23, s35, v67
    v_mul_f32 v22, v22, v14
    v_mul_f32 v23, v23, v15
    v_cvt_pk_bf16_f32 v67, v22, v23
    v_mfma_f32_16x16x32_bf16 v[236:239], v[112:115], v[52:55], v[236:239]
    v_lshlrev_b32 v20, 16, v68
    v_and_b32 v21, s35, v68
    v_mul_f32 v20, v20, v8
    v_mul_f32 v21, v21, v9
    v_mfma_f32_16x16x32_bf16 v[240:243], v[116:119], v[40:43], v[240:243]
    v_cvt_pk_bf16_f32 v68, v20, v21
    v_lshlrev_b32 v22, 16, v69
    v_and_b32 v23, s35, v69
    v_mul_f32 v22, v22, v10
    v_mfma_f32_16x16x32_bf16 v[244:247], v[116:119], v[44:47], v[244:247]
    v_mul_f32 v23, v23, v11
    v_cvt_pk_bf16_f32 v69, v22, v23
    v_lshlrev_b32 v20, 16, v70
    v_and_b32 v21, s35, v70
    v_mfma_f32_16x16x32_bf16 v[248:251], v[116:119], v[48:51], v[248:251]
    v_mul_f32 v20, v20, v12
    v_mul_f32 v21, v21, v13
    v_cvt_pk_bf16_f32 v70, v20, v21
    v_lshlrev_b32 v22, 16, v71
    v_mfma_f32_16x16x32_bf16 v[252:255], v[116:119], v[52:55], v[252:255]
    v_and_b32 v23, s35, v71
    v_mul_f32 v22, v22, v14
    v_mul_f32 v23, v23, v15
    v_cvt_pk_bf16_f32 v71, v22, v23
    ds_read_b128 v[8:11], v6 offset:1536
    ds_read_b128 v[12:15], v6 offset:1552
    s_waitcnt vmcnt(44)
    ds_read_b128 v[40:43], v26 offset:16384
    ds_read_b128 v[44:47], v26 offset:18432
    ds_read_b128 v[48:51], v26 offset:20480
    ds_read_b128 v[52:55], v26 offset:22528
    s_waitcnt lgkmcnt(6)
    buffer_load_dwordx4 v[96:99], v4, s[20:23], s27 offen offset:0
    buffer_load_dwordx4 v[100:103], v4, s[20:23], s27 offen offset:1024
    buffer_load_dwordx4 v[104:107], v4, s[20:23], s27 offen offset:2048
    buffer_load_dwordx4 v[108:111], v4, s[20:23], s27 offen offset:3072
    buffer_load_dwordx4 v[112:115], v5, s[20:23], s27 offen offset:0
    buffer_load_dwordx4 v[116:119], v5, s[20:23], s27 offen offset:1024
    s_add_u32 s27, s27, 6144
    s_waitcnt vmcnt(12)
    v_mfma_f32_16x16x32_bf16 v[144:147], v[16:19], v[56:59], v[144:147]
    v_mfma_f32_16x16x32_bf16 v[148:151], v[16:19], v[60:63], v[148:151]
    v_mfma_f32_16x16x32_bf16 v[152:155], v[16:19], v[64:67], v[152:155]
    v_mfma_f32_16x16x32_bf16 v[156:159], v[16:19], v[68:71], v[156:159]
    ds_read_b128 v[16:19], v7 offset:2816
    v_mfma_f32_16x16x32_bf16 v[160:163], v[120:123], v[56:59], v[160:163]
    v_mfma_f32_16x16x32_bf16 v[164:167], v[120:123], v[60:63], v[164:167]
    v_mfma_f32_16x16x32_bf16 v[168:171], v[120:123], v[64:67], v[168:171]
    v_mfma_f32_16x16x32_bf16 v[172:175], v[120:123], v[68:71], v[172:175]
    s_waitcnt lgkmcnt(1)
    v_mfma_f32_16x16x32_bf16 v[176:179], v[124:127], v[56:59], v[176:179]
    v_lshlrev_b32 v20, 16, v40
    v_and_b32 v21, s35, v40
    v_mul_f32 v20, v20, v8
    v_mul_f32 v21, v21, v9
    v_mfma_f32_16x16x32_bf16 v[180:183], v[124:127], v[60:63], v[180:183]
    v_cvt_pk_bf16_f32 v40, v20, v21
    v_lshlrev_b32 v22, 16, v41
    v_and_b32 v23, s35, v41
    v_mul_f32 v22, v22, v10
    v_mfma_f32_16x16x32_bf16 v[184:187], v[124:127], v[64:67], v[184:187]
    v_mul_f32 v23, v23, v11
    v_cvt_pk_bf16_f32 v41, v22, v23
    v_lshlrev_b32 v20, 16, v42
    v_and_b32 v21, s35, v42
    v_mfma_f32_16x16x32_bf16 v[188:191], v[124:127], v[68:71], v[188:191]
    v_mul_f32 v20, v20, v12
    v_mul_f32 v21, v21, v13
    v_cvt_pk_bf16_f32 v42, v20, v21
    v_lshlrev_b32 v22, 16, v43
    v_mfma_f32_16x16x32_bf16 v[192:195], v[128:131], v[56:59], v[192:195]
    v_and_b32 v23, s35, v43
    v_mul_f32 v22, v22, v14
    v_mul_f32 v23, v23, v15
    v_cvt_pk_bf16_f32 v43, v22, v23
    v_mfma_f32_16x16x32_bf16 v[196:199], v[128:131], v[60:63], v[196:199]
    v_lshlrev_b32 v20, 16, v44
    v_and_b32 v21, s35, v44
    v_mul_f32 v20, v20, v8
    v_mul_f32 v21, v21, v9
    v_mfma_f32_16x16x32_bf16 v[200:203], v[128:131], v[64:67], v[200:203]
    v_cvt_pk_bf16_f32 v44, v20, v21
    v_lshlrev_b32 v22, 16, v45
    v_and_b32 v23, s35, v45
    v_mul_f32 v22, v22, v10
    v_mfma_f32_16x16x32_bf16 v[204:207], v[128:131], v[68:71], v[204:207]
    v_mul_f32 v23, v23, v11
    v_cvt_pk_bf16_f32 v45, v22, v23
    v_lshlrev_b32 v20, 16, v46
    v_and_b32 v21, s35, v46
    v_mfma_f32_16x16x32_bf16 v[208:211], v[132:135], v[56:59], v[208:211]
    v_mul_f32 v20, v20, v12
    v_mul_f32 v21, v21, v13
    v_cvt_pk_bf16_f32 v46, v20, v21
    v_lshlrev_b32 v22, 16, v47
    v_mfma_f32_16x16x32_bf16 v[212:215], v[132:135], v[60:63], v[212:215]
    v_and_b32 v23, s35, v47
    v_mul_f32 v22, v22, v14
    v_mul_f32 v23, v23, v15
    v_cvt_pk_bf16_f32 v47, v22, v23
    v_mfma_f32_16x16x32_bf16 v[216:219], v[132:135], v[64:67], v[216:219]
    v_lshlrev_b32 v20, 16, v48
    v_and_b32 v21, s35, v48
    v_mul_f32 v20, v20, v8
    v_mul_f32 v21, v21, v9
    v_mfma_f32_16x16x32_bf16 v[220:223], v[132:135], v[68:71], v[220:223]
    v_cvt_pk_bf16_f32 v48, v20, v21
    v_lshlrev_b32 v22, 16, v49
    v_and_b32 v23, s35, v49
    v_mul_f32 v22, v22, v10
    v_mfma_f32_16x16x32_bf16 v[224:227], v[136:139], v[56:59], v[224:227]
    v_mul_f32 v23, v23, v11
    v_cvt_pk_bf16_f32 v49, v22, v23
    v_lshlrev_b32 v20, 16, v50
    v_and_b32 v21, s35, v50
    v_mfma_f32_16x16x32_bf16 v[228:231], v[136:139], v[60:63], v[228:231]
    v_mul_f32 v20, v20, v12
    v_mul_f32 v21, v21, v13
    v_cvt_pk_bf16_f32 v50, v20, v21
    v_lshlrev_b32 v22, 16, v51
    v_mfma_f32_16x16x32_bf16 v[232:235], v[136:139], v[64:67], v[232:235]
    v_and_b32 v23, s35, v51
    v_mul_f32 v22, v22, v14
    v_mul_f32 v23, v23, v15
    v_cvt_pk_bf16_f32 v51, v22, v23
    v_mfma_f32_16x16x32_bf16 v[236:239], v[136:139], v[68:71], v[236:239]
    v_lshlrev_b32 v20, 16, v52
    v_and_b32 v21, s35, v52
    v_mul_f32 v20, v20, v8
    v_mul_f32 v21, v21, v9
    v_mfma_f32_16x16x32_bf16 v[240:243], v[140:143], v[56:59], v[240:243]
    v_cvt_pk_bf16_f32 v52, v20, v21
    v_lshlrev_b32 v22, 16, v53
    v_and_b32 v23, s35, v53
    v_mul_f32 v22, v22, v10
    v_mfma_f32_16x16x32_bf16 v[244:247], v[140:143], v[60:63], v[244:247]
    v_mul_f32 v23, v23, v11
    v_cvt_pk_bf16_f32 v53, v22, v23
    v_lshlrev_b32 v20, 16, v54
    v_and_b32 v21, s35, v54
    v_mfma_f32_16x16x32_bf16 v[248:251], v[140:143], v[64:67], v[248:251]
    v_mul_f32 v20, v20, v12
    v_mul_f32 v21, v21, v13
    v_cvt_pk_bf16_f32 v54, v20, v21
    v_lshlrev_b32 v22, 16, v55
    v_mfma_f32_16x16x32_bf16 v[252:255], v[140:143], v[68:71], v[252:255]
    v_and_b32 v23, s35, v55
    v_mul_f32 v22, v22, v14
    v_mul_f32 v23, v23, v15
    v_cvt_pk_bf16_f32 v55, v22, v23
    ds_read_b128 v[8:11], v6 offset:1664
    ds_read_b128 v[12:15], v6 offset:1680
    ds_read_b128 v[56:59], v27 offset:16384
    ds_read_b128 v[60:63], v27 offset:18432
    ds_read_b128 v[64:67], v27 offset:20480
    ds_read_b128 v[68:71], v27 offset:22528
    s_waitcnt lgkmcnt(6)
    buffer_load_dwordx4 v[120:123], v4, s[20:23], s27 offen offset:0
    buffer_load_dwordx4 v[124:127], v4, s[20:23], s27 offen offset:1024
    buffer_load_dwordx4 v[128:131], v4, s[20:23], s27 offen offset:2048
    buffer_load_dwordx4 v[132:135], v4, s[20:23], s27 offen offset:3072
    buffer_load_dwordx4 v[136:139], v5, s[20:23], s27 offen offset:0
    buffer_load_dwordx4 v[140:143], v5, s[20:23], s27 offen offset:1024
    s_add_u32 s27, s27, 6144
    s_waitcnt vmcnt(12)
    v_mfma_f32_16x16x32_bf16 v[144:147], v[16:19], v[40:43], v[144:147]
    v_mfma_f32_16x16x32_bf16 v[148:151], v[16:19], v[44:47], v[148:151]
    v_mfma_f32_16x16x32_bf16 v[152:155], v[16:19], v[48:51], v[152:155]
    v_mfma_f32_16x16x32_bf16 v[156:159], v[16:19], v[52:55], v[156:159]
    ds_read_b128 v[16:19], v7 offset:2880
    v_mfma_f32_16x16x32_bf16 v[160:163], v[72:75], v[40:43], v[160:163]
    v_mfma_f32_16x16x32_bf16 v[164:167], v[72:75], v[44:47], v[164:167]
    v_mfma_f32_16x16x32_bf16 v[168:171], v[72:75], v[48:51], v[168:171]
    v_mfma_f32_16x16x32_bf16 v[172:175], v[72:75], v[52:55], v[172:175]
    s_waitcnt lgkmcnt(1)
    v_mfma_f32_16x16x32_bf16 v[176:179], v[76:79], v[40:43], v[176:179]
    v_lshlrev_b32 v20, 16, v56
    v_and_b32 v21, s35, v56
    v_mul_f32 v20, v20, v8
    v_mul_f32 v21, v21, v9
    v_mfma_f32_16x16x32_bf16 v[180:183], v[76:79], v[44:47], v[180:183]
    v_cvt_pk_bf16_f32 v56, v20, v21
    v_lshlrev_b32 v22, 16, v57
    v_and_b32 v23, s35, v57
    v_mul_f32 v22, v22, v10
    v_mfma_f32_16x16x32_bf16 v[184:187], v[76:79], v[48:51], v[184:187]
    v_mul_f32 v23, v23, v11
    v_cvt_pk_bf16_f32 v57, v22, v23
    v_lshlrev_b32 v20, 16, v58
    v_and_b32 v21, s35, v58
    v_mfma_f32_16x16x32_bf16 v[188:191], v[76:79], v[52:55], v[188:191]
    v_mul_f32 v20, v20, v12
    v_mul_f32 v21, v21, v13
    v_cvt_pk_bf16_f32 v58, v20, v21
    v_lshlrev_b32 v22, 16, v59
    v_mfma_f32_16x16x32_bf16 v[192:195], v[80:83], v[40:43], v[192:195]
    v_and_b32 v23, s35, v59
    v_mul_f32 v22, v22, v14
    v_mul_f32 v23, v23, v15
    v_cvt_pk_bf16_f32 v59, v22, v23
    v_mfma_f32_16x16x32_bf16 v[196:199], v[80:83], v[44:47], v[196:199]
    v_lshlrev_b32 v20, 16, v60
    v_and_b32 v21, s35, v60
    v_mul_f32 v20, v20, v8
    v_mul_f32 v21, v21, v9
    v_mfma_f32_16x16x32_bf16 v[200:203], v[80:83], v[48:51], v[200:203]
    v_cvt_pk_bf16_f32 v60, v20, v21
    v_lshlrev_b32 v22, 16, v61
    v_and_b32 v23, s35, v61
    v_mul_f32 v22, v22, v10
    v_mfma_f32_16x16x32_bf16 v[204:207], v[80:83], v[52:55], v[204:207]
    v_mul_f32 v23, v23, v11
    v_cvt_pk_bf16_f32 v61, v22, v23
    v_lshlrev_b32 v20, 16, v62
    v_and_b32 v21, s35, v62
    v_mfma_f32_16x16x32_bf16 v[208:211], v[84:87], v[40:43], v[208:211]
    v_mul_f32 v20, v20, v12
    v_mul_f32 v21, v21, v13
    v_cvt_pk_bf16_f32 v62, v20, v21
    v_lshlrev_b32 v22, 16, v63
    v_mfma_f32_16x16x32_bf16 v[212:215], v[84:87], v[44:47], v[212:215]
    v_and_b32 v23, s35, v63
    v_mul_f32 v22, v22, v14
    v_mul_f32 v23, v23, v15
    v_cvt_pk_bf16_f32 v63, v22, v23
    v_mfma_f32_16x16x32_bf16 v[216:219], v[84:87], v[48:51], v[216:219]
    v_lshlrev_b32 v20, 16, v64
    v_and_b32 v21, s35, v64
    v_mul_f32 v20, v20, v8
    v_mul_f32 v21, v21, v9
    v_mfma_f32_16x16x32_bf16 v[220:223], v[84:87], v[52:55], v[220:223]
    v_cvt_pk_bf16_f32 v64, v20, v21
    v_lshlrev_b32 v22, 16, v65
    v_and_b32 v23, s35, v65
    v_mul_f32 v22, v22, v10
    v_mfma_f32_16x16x32_bf16 v[224:227], v[88:91], v[40:43], v[224:227]
    v_mul_f32 v23, v23, v11
    v_cvt_pk_bf16_f32 v65, v22, v23
    v_lshlrev_b32 v20, 16, v66
    v_and_b32 v21, s35, v66
    v_mfma_f32_16x16x32_bf16 v[228:231], v[88:91], v[44:47], v[228:231]
    v_mul_f32 v20, v20, v12
    v_mul_f32 v21, v21, v13
    v_cvt_pk_bf16_f32 v66, v20, v21
    v_lshlrev_b32 v22, 16, v67
    v_mfma_f32_16x16x32_bf16 v[232:235], v[88:91], v[48:51], v[232:235]
    v_and_b32 v23, s35, v67
    v_mul_f32 v22, v22, v14
    v_mul_f32 v23, v23, v15
    v_cvt_pk_bf16_f32 v67, v22, v23
    v_mfma_f32_16x16x32_bf16 v[236:239], v[88:91], v[52:55], v[236:239]
    v_lshlrev_b32 v20, 16, v68
    v_and_b32 v21, s35, v68
    v_mul_f32 v20, v20, v8
    v_mul_f32 v21, v21, v9
    v_mfma_f32_16x16x32_bf16 v[240:243], v[92:95], v[40:43], v[240:243]
    v_cvt_pk_bf16_f32 v68, v20, v21
    v_lshlrev_b32 v22, 16, v69
    v_and_b32 v23, s35, v69
    v_mul_f32 v22, v22, v10
    v_mfma_f32_16x16x32_bf16 v[244:247], v[92:95], v[44:47], v[244:247]
    v_mul_f32 v23, v23, v11
    v_cvt_pk_bf16_f32 v69, v22, v23
    v_lshlrev_b32 v20, 16, v70
    v_and_b32 v21, s35, v70
    v_mfma_f32_16x16x32_bf16 v[248:251], v[92:95], v[48:51], v[248:251]
    v_mul_f32 v20, v20, v12
    v_mul_f32 v21, v21, v13
    v_cvt_pk_bf16_f32 v70, v20, v21
    v_lshlrev_b32 v22, 16, v71
    v_mfma_f32_16x16x32_bf16 v[252:255], v[92:95], v[52:55], v[252:255]
    v_and_b32 v23, s35, v71
    v_mul_f32 v22, v22, v14
    v_mul_f32 v23, v23, v15
    v_cvt_pk_bf16_f32 v71, v22, v23
    ds_read_b128 v[8:11], v6 offset:1792
    ds_read_b128 v[12:15], v6 offset:1808
    s_waitcnt vmcnt(36)
    ds_read_b128 v[40:43], v26 offset:24576
    ds_read_b128 v[44:47], v26 offset:26624
    ds_read_b128 v[48:51], v26 offset:28672
    ds_read_b128 v[52:55], v26 offset:30720
    s_waitcnt lgkmcnt(6)
    buffer_load_dwordx4 v[72:75], v4, s[20:23], s27 offen offset:0
    buffer_load_dwordx4 v[76:79], v4, s[20:23], s27 offen offset:1024
    buffer_load_dwordx4 v[80:83], v4, s[20:23], s27 offen offset:2048
    buffer_load_dwordx4 v[84:87], v4, s[20:23], s27 offen offset:3072
    buffer_load_dwordx4 v[88:91], v5, s[20:23], s27 offen offset:0
    buffer_load_dwordx4 v[92:95], v5, s[20:23], s27 offen offset:1024
    s_add_u32 s27, s27, 6144
    s_waitcnt vmcnt(12)
    v_mfma_f32_16x16x32_bf16 v[144:147], v[16:19], v[56:59], v[144:147]
    v_mfma_f32_16x16x32_bf16 v[148:151], v[16:19], v[60:63], v[148:151]
    v_mfma_f32_16x16x32_bf16 v[152:155], v[16:19], v[64:67], v[152:155]
    v_mfma_f32_16x16x32_bf16 v[156:159], v[16:19], v[68:71], v[156:159]
    ds_read_b128 v[16:19], v7 offset:2944
    v_mfma_f32_16x16x32_bf16 v[160:163], v[96:99], v[56:59], v[160:163]
    v_mfma_f32_16x16x32_bf16 v[164:167], v[96:99], v[60:63], v[164:167]
    v_mfma_f32_16x16x32_bf16 v[168:171], v[96:99], v[64:67], v[168:171]
    v_mfma_f32_16x16x32_bf16 v[172:175], v[96:99], v[68:71], v[172:175]
    s_waitcnt lgkmcnt(1)
    v_mfma_f32_16x16x32_bf16 v[176:179], v[100:103], v[56:59], v[176:179]
    v_lshlrev_b32 v20, 16, v40
    v_and_b32 v21, s35, v40
    v_mul_f32 v20, v20, v8
    v_mul_f32 v21, v21, v9
    v_mfma_f32_16x16x32_bf16 v[180:183], v[100:103], v[60:63], v[180:183]
    v_cvt_pk_bf16_f32 v40, v20, v21
    v_lshlrev_b32 v22, 16, v41
    v_and_b32 v23, s35, v41
    v_mul_f32 v22, v22, v10
    v_mfma_f32_16x16x32_bf16 v[184:187], v[100:103], v[64:67], v[184:187]
    v_mul_f32 v23, v23, v11
    v_cvt_pk_bf16_f32 v41, v22, v23
    v_lshlrev_b32 v20, 16, v42
    v_and_b32 v21, s35, v42
    v_mfma_f32_16x16x32_bf16 v[188:191], v[100:103], v[68:71], v[188:191]
    v_mul_f32 v20, v20, v12
    v_mul_f32 v21, v21, v13
    v_cvt_pk_bf16_f32 v42, v20, v21
    v_lshlrev_b32 v22, 16, v43
    v_mfma_f32_16x16x32_bf16 v[192:195], v[104:107], v[56:59], v[192:195]
    v_and_b32 v23, s35, v43
    v_mul_f32 v22, v22, v14
    v_mul_f32 v23, v23, v15
    v_cvt_pk_bf16_f32 v43, v22, v23
    v_mfma_f32_16x16x32_bf16 v[196:199], v[104:107], v[60:63], v[196:199]
    v_lshlrev_b32 v20, 16, v44
    v_and_b32 v21, s35, v44
    v_mul_f32 v20, v20, v8
    v_mul_f32 v21, v21, v9
    v_mfma_f32_16x16x32_bf16 v[200:203], v[104:107], v[64:67], v[200:203]
    v_cvt_pk_bf16_f32 v44, v20, v21
    v_lshlrev_b32 v22, 16, v45
    v_and_b32 v23, s35, v45
    v_mul_f32 v22, v22, v10
    v_mfma_f32_16x16x32_bf16 v[204:207], v[104:107], v[68:71], v[204:207]
    v_mul_f32 v23, v23, v11
    v_cvt_pk_bf16_f32 v45, v22, v23
    v_lshlrev_b32 v20, 16, v46
    v_and_b32 v21, s35, v46
    v_mfma_f32_16x16x32_bf16 v[208:211], v[108:111], v[56:59], v[208:211]
    v_mul_f32 v20, v20, v12
    v_mul_f32 v21, v21, v13
    v_cvt_pk_bf16_f32 v46, v20, v21
    v_lshlrev_b32 v22, 16, v47
    v_mfma_f32_16x16x32_bf16 v[212:215], v[108:111], v[60:63], v[212:215]
    v_and_b32 v23, s35, v47
    v_mul_f32 v22, v22, v14
    v_mul_f32 v23, v23, v15
    v_cvt_pk_bf16_f32 v47, v22, v23
    v_mfma_f32_16x16x32_bf16 v[216:219], v[108:111], v[64:67], v[216:219]
    v_lshlrev_b32 v20, 16, v48
    v_and_b32 v21, s35, v48
    v_mul_f32 v20, v20, v8
    v_mul_f32 v21, v21, v9
    v_mfma_f32_16x16x32_bf16 v[220:223], v[108:111], v[68:71], v[220:223]
    v_cvt_pk_bf16_f32 v48, v20, v21
    v_lshlrev_b32 v22, 16, v49
    v_and_b32 v23, s35, v49
    v_mul_f32 v22, v22, v10
    v_mfma_f32_16x16x32_bf16 v[224:227], v[112:115], v[56:59], v[224:227]
    v_mul_f32 v23, v23, v11
    v_cvt_pk_bf16_f32 v49, v22, v23
    v_lshlrev_b32 v20, 16, v50
    v_and_b32 v21, s35, v50
    v_mfma_f32_16x16x32_bf16 v[228:231], v[112:115], v[60:63], v[228:231]
    v_mul_f32 v20, v20, v12
    v_mul_f32 v21, v21, v13
    v_cvt_pk_bf16_f32 v50, v20, v21
    v_lshlrev_b32 v22, 16, v51
    v_mfma_f32_16x16x32_bf16 v[232:235], v[112:115], v[64:67], v[232:235]
    v_and_b32 v23, s35, v51
    v_mul_f32 v22, v22, v14
    v_mul_f32 v23, v23, v15
    v_cvt_pk_bf16_f32 v51, v22, v23
    v_mfma_f32_16x16x32_bf16 v[236:239], v[112:115], v[68:71], v[236:239]
    v_lshlrev_b32 v20, 16, v52
    v_and_b32 v21, s35, v52
    v_mul_f32 v20, v20, v8
    v_mul_f32 v21, v21, v9
    v_mfma_f32_16x16x32_bf16 v[240:243], v[116:119], v[56:59], v[240:243]
    v_cvt_pk_bf16_f32 v52, v20, v21
    v_lshlrev_b32 v22, 16, v53
    v_and_b32 v23, s35, v53
    v_mul_f32 v22, v22, v10
    v_mfma_f32_16x16x32_bf16 v[244:247], v[116:119], v[60:63], v[244:247]
    v_mul_f32 v23, v23, v11
    v_cvt_pk_bf16_f32 v53, v22, v23
    v_lshlrev_b32 v20, 16, v54
    v_and_b32 v21, s35, v54
    v_mfma_f32_16x16x32_bf16 v[248:251], v[116:119], v[64:67], v[248:251]
    v_mul_f32 v20, v20, v12
    v_mul_f32 v21, v21, v13
    v_cvt_pk_bf16_f32 v54, v20, v21
    v_lshlrev_b32 v22, 16, v55
    v_mfma_f32_16x16x32_bf16 v[252:255], v[116:119], v[68:71], v[252:255]
    v_and_b32 v23, s35, v55
    v_mul_f32 v22, v22, v14
    v_mul_f32 v23, v23, v15
    v_cvt_pk_bf16_f32 v55, v22, v23
    ds_read_b128 v[8:11], v6 offset:1920
    ds_read_b128 v[12:15], v6 offset:1936
    ds_read_b128 v[56:59], v27 offset:24576
    ds_read_b128 v[60:63], v27 offset:26624
    ds_read_b128 v[64:67], v27 offset:28672
    ds_read_b128 v[68:71], v27 offset:30720
    s_waitcnt lgkmcnt(6)
    s_lshl_b32 s32, s24, 6
    s_lshl_b32 s33, s26, 4
    s_add_u32 s32, s32, s33
    v_add_u32 v28, s32, v2
    v_lshlrev_b32 v29, 1, v28
    buffer_load_ushort v108, v29, s[16:19], 0 offen
    v_mul_u32_u24 v29, 1536, v28
    v_mul_u32_u24 v30, 48, v3
    v_add_u32 v29, v29, v30
    s_mul_i32 s34, s25, 192
    s_add_u32 s34, s34, 7864320
    buffer_load_dwordx4 v[96:99], v29, s[20:23], s34 offen offset:0
    buffer_load_dwordx4 v[100:103], v29, s[20:23], s34 offen offset:16
    buffer_load_dwordx4 v[104:107], v29, s[20:23], s34 offen offset:32
    s_waitcnt vmcnt(10)
    v_mfma_f32_16x16x32_bf16 v[144:147], v[16:19], v[40:43], v[144:147]
    v_mfma_f32_16x16x32_bf16 v[148:151], v[16:19], v[44:47], v[148:151]
    v_mfma_f32_16x16x32_bf16 v[152:155], v[16:19], v[48:51], v[152:155]
    v_mfma_f32_16x16x32_bf16 v[156:159], v[16:19], v[52:55], v[156:159]
    ds_read_b128 v[16:19], v7 offset:3008
    v_mfma_f32_16x16x32_bf16 v[160:163], v[120:123], v[40:43], v[160:163]
    v_mfma_f32_16x16x32_bf16 v[164:167], v[120:123], v[44:47], v[164:167]
    v_mfma_f32_16x16x32_bf16 v[168:171], v[120:123], v[48:51], v[168:171]
    v_mfma_f32_16x16x32_bf16 v[172:175], v[120:123], v[52:55], v[172:175]
    s_waitcnt lgkmcnt(1)
    v_mfma_f32_16x16x32_bf16 v[176:179], v[124:127], v[40:43], v[176:179]
    v_lshlrev_b32 v20, 16, v56
    v_and_b32 v21, s35, v56
    v_mul_f32 v20, v20, v8
    v_mul_f32 v21, v21, v9
    v_mfma_f32_16x16x32_bf16 v[180:183], v[124:127], v[44:47], v[180:183]
    v_cvt_pk_bf16_f32 v56, v20, v21
    v_lshlrev_b32 v22, 16, v57
    v_and_b32 v23, s35, v57
    v_mul_f32 v22, v22, v10
    v_mfma_f32_16x16x32_bf16 v[184:187], v[124:127], v[48:51], v[184:187]
    v_mul_f32 v23, v23, v11
    v_cvt_pk_bf16_f32 v57, v22, v23
    v_lshlrev_b32 v20, 16, v58
    v_and_b32 v21, s35, v58
    v_mfma_f32_16x16x32_bf16 v[188:191], v[124:127], v[52:55], v[188:191]
    v_mul_f32 v20, v20, v12
    v_mul_f32 v21, v21, v13
    v_cvt_pk_bf16_f32 v58, v20, v21
    v_lshlrev_b32 v22, 16, v59
    v_mfma_f32_16x16x32_bf16 v[192:195], v[128:131], v[40:43], v[192:195]
    v_and_b32 v23, s35, v59
    v_mul_f32 v22, v22, v14
    v_mul_f32 v23, v23, v15
    v_cvt_pk_bf16_f32 v59, v22, v23
    v_mfma_f32_16x16x32_bf16 v[196:199], v[128:131], v[44:47], v[196:199]
    v_lshlrev_b32 v20, 16, v60
    v_and_b32 v21, s35, v60
    v_mul_f32 v20, v20, v8
    v_mul_f32 v21, v21, v9
    v_mfma_f32_16x16x32_bf16 v[200:203], v[128:131], v[48:51], v[200:203]
    v_cvt_pk_bf16_f32 v60, v20, v21
    v_lshlrev_b32 v22, 16, v61
    v_and_b32 v23, s35, v61
    v_mul_f32 v22, v22, v10
    v_mfma_f32_16x16x32_bf16 v[204:207], v[128:131], v[52:55], v[204:207]
    v_mul_f32 v23, v23, v11
    v_cvt_pk_bf16_f32 v61, v22, v23
    v_lshlrev_b32 v20, 16, v62
    v_and_b32 v21, s35, v62
    v_mfma_f32_16x16x32_bf16 v[208:211], v[132:135], v[40:43], v[208:211]
    v_mul_f32 v20, v20, v12
    v_mul_f32 v21, v21, v13
    v_cvt_pk_bf16_f32 v62, v20, v21
    v_lshlrev_b32 v22, 16, v63
    v_mfma_f32_16x16x32_bf16 v[212:215], v[132:135], v[44:47], v[212:215]
    v_and_b32 v23, s35, v63
    v_mul_f32 v22, v22, v14
    v_mul_f32 v23, v23, v15
    v_cvt_pk_bf16_f32 v63, v22, v23
    v_mfma_f32_16x16x32_bf16 v[216:219], v[132:135], v[48:51], v[216:219]
    v_lshlrev_b32 v20, 16, v64
    v_and_b32 v21, s35, v64
    v_mul_f32 v20, v20, v8
    v_mul_f32 v21, v21, v9
    v_mfma_f32_16x16x32_bf16 v[220:223], v[132:135], v[52:55], v[220:223]
    v_cvt_pk_bf16_f32 v64, v20, v21
    v_lshlrev_b32 v22, 16, v65
    v_and_b32 v23, s35, v65
    v_mul_f32 v22, v22, v10
    v_mfma_f32_16x16x32_bf16 v[224:227], v[136:139], v[40:43], v[224:227]
    v_mul_f32 v23, v23, v11
    v_cvt_pk_bf16_f32 v65, v22, v23
    v_lshlrev_b32 v20, 16, v66
    v_and_b32 v21, s35, v66
    v_mfma_f32_16x16x32_bf16 v[228:231], v[136:139], v[44:47], v[228:231]
    v_mul_f32 v20, v20, v12
    v_mul_f32 v21, v21, v13
    v_cvt_pk_bf16_f32 v66, v20, v21
    v_lshlrev_b32 v22, 16, v67
    v_mfma_f32_16x16x32_bf16 v[232:235], v[136:139], v[48:51], v[232:235]
    v_and_b32 v23, s35, v67
    v_mul_f32 v22, v22, v14
    v_mul_f32 v23, v23, v15
    v_cvt_pk_bf16_f32 v67, v22, v23
    v_mfma_f32_16x16x32_bf16 v[236:239], v[136:139], v[52:55], v[236:239]
    v_lshlrev_b32 v20, 16, v68
    v_and_b32 v21, s35, v68
    v_mul_f32 v20, v20, v8
    v_mul_f32 v21, v21, v9
    v_mfma_f32_16x16x32_bf16 v[240:243], v[140:143], v[40:43], v[240:243]
    v_cvt_pk_bf16_f32 v68, v20, v21
    v_lshlrev_b32 v22, 16, v69
    v_and_b32 v23, s35, v69
    v_mul_f32 v22, v22, v10
    v_mfma_f32_16x16x32_bf16 v[244:247], v[140:143], v[44:47], v[244:247]
    v_mul_f32 v23, v23, v11
    v_cvt_pk_bf16_f32 v69, v22, v23
    v_lshlrev_b32 v20, 16, v70
    v_and_b32 v21, s35, v70
    v_mfma_f32_16x16x32_bf16 v[248:251], v[140:143], v[48:51], v[248:251]
    v_mul_f32 v20, v20, v12
    v_mul_f32 v21, v21, v13
    v_cvt_pk_bf16_f32 v70, v20, v21
    v_lshlrev_b32 v22, 16, v71
    v_mfma_f32_16x16x32_bf16 v[252:255], v[140:143], v[52:55], v[252:255]
    v_and_b32 v23, s35, v71
    v_mul_f32 v22, v22, v14
    v_mul_f32 v23, v23, v15
    v_cvt_pk_bf16_f32 v71, v22, v23
    s_waitcnt lgkmcnt(0)
    s_waitcnt vmcnt(4)
    v_mfma_f32_16x16x32_bf16 v[144:147], v[16:19], v[56:59], v[144:147]
    v_mfma_f32_16x16x32_bf16 v[148:151], v[16:19], v[60:63], v[148:151]
    v_mfma_f32_16x16x32_bf16 v[152:155], v[16:19], v[64:67], v[152:155]
    v_mfma_f32_16x16x32_bf16 v[156:159], v[16:19], v[68:71], v[156:159]
    v_mfma_f32_16x16x32_bf16 v[160:163], v[72:75], v[56:59], v[160:163]
    v_mfma_f32_16x16x32_bf16 v[164:167], v[72:75], v[60:63], v[164:167]
    v_mfma_f32_16x16x32_bf16 v[168:171], v[72:75], v[64:67], v[168:171]
    v_mfma_f32_16x16x32_bf16 v[172:175], v[72:75], v[68:71], v[172:175]
    v_mfma_f32_16x16x32_bf16 v[176:179], v[76:79], v[56:59], v[176:179]
    v_mfma_f32_16x16x32_bf16 v[180:183], v[76:79], v[60:63], v[180:183]
    v_mfma_f32_16x16x32_bf16 v[184:187], v[76:79], v[64:67], v[184:187]
    v_mfma_f32_16x16x32_bf16 v[188:191], v[76:79], v[68:71], v[188:191]
    v_mfma_f32_16x16x32_bf16 v[192:195], v[80:83], v[56:59], v[192:195]
    v_mfma_f32_16x16x32_bf16 v[196:199], v[80:83], v[60:63], v[196:199]
    v_mfma_f32_16x16x32_bf16 v[200:203], v[80:83], v[64:67], v[200:203]
    v_mfma_f32_16x16x32_bf16 v[204:207], v[80:83], v[68:71], v[204:207]
    v_mfma_f32_16x16x32_bf16 v[208:211], v[84:87], v[56:59], v[208:211]
    v_mfma_f32_16x16x32_bf16 v[212:215], v[84:87], v[60:63], v[212:215]
    v_mfma_f32_16x16x32_bf16 v[216:219], v[84:87], v[64:67], v[216:219]
    v_mfma_f32_16x16x32_bf16 v[220:223], v[84:87], v[68:71], v[220:223]
    v_mfma_f32_16x16x32_bf16 v[224:227], v[88:91], v[56:59], v[224:227]
    v_mfma_f32_16x16x32_bf16 v[228:231], v[88:91], v[60:63], v[228:231]
    v_mfma_f32_16x16x32_bf16 v[232:235], v[88:91], v[64:67], v[232:235]
    v_mfma_f32_16x16x32_bf16 v[236:239], v[88:91], v[68:71], v[236:239]
    v_mfma_f32_16x16x32_bf16 v[240:243], v[92:95], v[56:59], v[240:243]
    v_mfma_f32_16x16x32_bf16 v[244:247], v[92:95], v[60:63], v[244:247]
    v_mfma_f32_16x16x32_bf16 v[248:251], v[92:95], v[64:67], v[248:251]
    v_mfma_f32_16x16x32_bf16 v[252:255], v[92:95], v[68:71], v[252:255]
    s_barrier
    v_lshlrev_b32 v22, 3, v1
    s_cmp_eq_u32 s26, 0
    s_cbranch_scc1 K2_SK_1001
    s_cmp_gt_u32 s26, 0
    s_cselect_b32 s36, 1, 0
    s_sub_u32 s36, s26, s36
    s_add_u32 s36, s36, 0
    s_mul_i32 s37, s36, 6144
    v_add_u32 v23, s37, v4
    ds_write_b128 v23, v[160:163] offset:0
    ds_write_b128 v23, v[176:179] offset:1024
    ds_write_b128 v23, v[192:195] offset:2048
    ds_write_b128 v23, v[208:211] offset:3072
    ds_write_b128 v23, v[224:227] offset:4096
    ds_write_b128 v23, v[240:243] offset:5120
    s_lshl_b32 s37, s36, 9
    v_add_u32 v23, s37, v22
    v_add_u32 v23, 73728, v23
    ds_write_b64 v23, v[144:145]
K2_SK_1001:
    s_cmp_eq_u32 s26, 1
    s_cbranch_scc1 K2_SK_1002
    s_cmp_gt_u32 s26, 1
    s_cselect_b32 s36, 1, 0
    s_sub_u32 s36, s26, s36
    s_add_u32 s36, s36, 3
    s_mul_i32 s37, s36, 6144
    v_add_u32 v23, s37, v4
    ds_write_b128 v23, v[164:167] offset:0
    ds_write_b128 v23, v[180:183] offset:1024
    ds_write_b128 v23, v[196:199] offset:2048
    ds_write_b128 v23, v[212:215] offset:3072
    ds_write_b128 v23, v[228:231] offset:4096
    ds_write_b128 v23, v[244:247] offset:5120
    s_lshl_b32 s37, s36, 9
    v_add_u32 v23, s37, v22
    v_add_u32 v23, 73728, v23
    ds_write_b64 v23, v[148:149]
K2_SK_1002:
    s_cmp_eq_u32 s26, 2
    s_cbranch_scc1 K2_SK_1003
    s_cmp_gt_u32 s26, 2
    s_cselect_b32 s36, 1, 0
    s_sub_u32 s36, s26, s36
    s_add_u32 s36, s36, 6
    s_mul_i32 s37, s36, 6144
    v_add_u32 v23, s37, v4
    ds_write_b128 v23, v[168:171] offset:0
    ds_write_b128 v23, v[184:187] offset:1024
    ds_write_b128 v23, v[200:203] offset:2048
    ds_write_b128 v23, v[216:219] offset:3072
    ds_write_b128 v23, v[232:235] offset:4096
    ds_write_b128 v23, v[248:251] offset:5120
    s_lshl_b32 s37, s36, 9
    v_add_u32 v23, s37, v22
    v_add_u32 v23, 73728, v23
    ds_write_b64 v23, v[152:153]
K2_SK_1003:
    s_cmp_eq_u32 s26, 3
    s_cbranch_scc1 K2_SK_1004
    s_cmp_gt_u32 s26, 3
    s_cselect_b32 s36, 1, 0
    s_sub_u32 s36, s26, s36
    s_add_u32 s36, s36, 9
    s_mul_i32 s37, s36, 6144
    v_add_u32 v23, s37, v4
    ds_write_b128 v23, v[172:175] offset:0
    ds_write_b128 v23, v[188:191] offset:1024
    ds_write_b128 v23, v[204:207] offset:2048
    ds_write_b128 v23, v[220:223] offset:3072
    ds_write_b128 v23, v[236:239] offset:4096
    ds_write_b128 v23, v[252:255] offset:5120
    s_lshl_b32 s37, s36, 9
    v_add_u32 v23, s37, v22
    v_add_u32 v23, 73728, v23
    ds_write_b64 v23, v[156:157]
K2_SK_1004:
    s_cmp_lg_u32 s26, 0
    s_cbranch_scc1 K2_MV_1005
    v_mov_b32 v40, v160
    v_mov_b32 v41, v161
    v_mov_b32 v42, v162
    v_mov_b32 v43, v163
    v_mov_b32 v44, v176
    v_mov_b32 v45, v177
    v_mov_b32 v46, v178
    v_mov_b32 v47, v179
    v_mov_b32 v48, v192
    v_mov_b32 v49, v193
    v_mov_b32 v50, v194
    v_mov_b32 v51, v195
    v_mov_b32 v52, v208
    v_mov_b32 v53, v209
    v_mov_b32 v54, v210
    v_mov_b32 v55, v211
    v_mov_b32 v56, v224
    v_mov_b32 v57, v225
    v_mov_b32 v58, v226
    v_mov_b32 v59, v227
    v_mov_b32 v60, v240
    v_mov_b32 v61, v241
    v_mov_b32 v62, v242
    v_mov_b32 v63, v243
    v_mov_b32 v64, v144
    v_mov_b32 v65, v145
K2_MV_1005:
    s_cmp_lg_u32 s26, 1
    s_cbranch_scc1 K2_MV_1006
    v_mov_b32 v40, v164
    v_mov_b32 v41, v165
    v_mov_b32 v42, v166
    v_mov_b32 v43, v167
    v_mov_b32 v44, v180
    v_mov_b32 v45, v181
    v_mov_b32 v46, v182
    v_mov_b32 v47, v183
    v_mov_b32 v48, v196
    v_mov_b32 v49, v197
    v_mov_b32 v50, v198
    v_mov_b32 v51, v199
    v_mov_b32 v52, v212
    v_mov_b32 v53, v213
    v_mov_b32 v54, v214
    v_mov_b32 v55, v215
    v_mov_b32 v56, v228
    v_mov_b32 v57, v229
    v_mov_b32 v58, v230
    v_mov_b32 v59, v231
    v_mov_b32 v60, v244
    v_mov_b32 v61, v245
    v_mov_b32 v62, v246
    v_mov_b32 v63, v247
    v_mov_b32 v64, v148
    v_mov_b32 v65, v149
K2_MV_1006:
    s_cmp_lg_u32 s26, 2
    s_cbranch_scc1 K2_MV_1007
    v_mov_b32 v40, v168
    v_mov_b32 v41, v169
    v_mov_b32 v42, v170
    v_mov_b32 v43, v171
    v_mov_b32 v44, v184
    v_mov_b32 v45, v185
    v_mov_b32 v46, v186
    v_mov_b32 v47, v187
    v_mov_b32 v48, v200
    v_mov_b32 v49, v201
    v_mov_b32 v50, v202
    v_mov_b32 v51, v203
    v_mov_b32 v52, v216
    v_mov_b32 v53, v217
    v_mov_b32 v54, v218
    v_mov_b32 v55, v219
    v_mov_b32 v56, v232
    v_mov_b32 v57, v233
    v_mov_b32 v58, v234
    v_mov_b32 v59, v235
    v_mov_b32 v60, v248
    v_mov_b32 v61, v249
    v_mov_b32 v62, v250
    v_mov_b32 v63, v251
    v_mov_b32 v64, v152
    v_mov_b32 v65, v153
K2_MV_1007:
    s_cmp_lg_u32 s26, 3
    s_cbranch_scc1 K2_MV_1008
    v_mov_b32 v40, v172
    v_mov_b32 v41, v173
    v_mov_b32 v42, v174
    v_mov_b32 v43, v175
    v_mov_b32 v44, v188
    v_mov_b32 v45, v189
    v_mov_b32 v46, v190
    v_mov_b32 v47, v191
    v_mov_b32 v48, v204
    v_mov_b32 v49, v205
    v_mov_b32 v50, v206
    v_mov_b32 v51, v207
    v_mov_b32 v52, v220
    v_mov_b32 v53, v221
    v_mov_b32 v54, v222
    v_mov_b32 v55, v223
    v_mov_b32 v56, v236
    v_mov_b32 v57, v237
    v_mov_b32 v58, v238
    v_mov_b32 v59, v239
    v_mov_b32 v60, v252
    v_mov_b32 v61, v253
    v_mov_b32 v62, v254
    v_mov_b32 v63, v255
    v_mov_b32 v64, v156
    v_mov_b32 v65, v157
K2_MV_1008:
    s_waitcnt lgkmcnt(0)
    s_barrier
    s_mul_i32 s37, s26, 18432
    v_add_u32 v23, s37, v4
    s_mul_i32 s37, s26, 1536
    s_add_u32 s37, s37, 73728
    v_add_u32 v22, s37, v22
    ds_read_b128 v[112:115], v23 offset:0
    ds_read_b128 v[116:119], v23 offset:1024
    ds_read_b128 v[120:123], v23 offset:2048
    ds_read_b128 v[124:127], v23 offset:3072
    ds_read_b128 v[128:131], v23 offset:4096
    ds_read_b128 v[132:135], v23 offset:5120
    ds_read_b64 v[136:137], v22 offset:0
    ds_read_b128 v[140:143], v23 offset:6144
    ds_read_b128 v[144:147], v23 offset:7168
    ds_read_b128 v[148:151], v23 offset:8192
    ds_read_b128 v[152:155], v23 offset:9216
    ds_read_b128 v[156:159], v23 offset:10240
    ds_read_b128 v[160:163], v23 offset:11264
    ds_read_b64 v[164:165], v22 offset:512
    ds_read_b128 v[168:171], v23 offset:12288
    ds_read_b128 v[172:175], v23 offset:13312
    ds_read_b128 v[176:179], v23 offset:14336
    ds_read_b128 v[180:183], v23 offset:15360
    ds_read_b128 v[184:187], v23 offset:16384
    ds_read_b128 v[188:191], v23 offset:17408
    ds_read_b64 v[192:193], v22 offset:1024
    s_waitcnt lgkmcnt(0)
    v_add_f32 v40, v40, v112
    v_add_f32 v41, v41, v113
    v_add_f32 v42, v42, v114
    v_add_f32 v43, v43, v115
    v_add_f32 v44, v44, v116
    v_add_f32 v45, v45, v117
    v_add_f32 v46, v46, v118
    v_add_f32 v47, v47, v119
    v_add_f32 v48, v48, v120
    v_add_f32 v49, v49, v121
    v_add_f32 v50, v50, v122
    v_add_f32 v51, v51, v123
    v_add_f32 v52, v52, v124
    v_add_f32 v53, v53, v125
    v_add_f32 v54, v54, v126
    v_add_f32 v55, v55, v127
    v_add_f32 v56, v56, v128
    v_add_f32 v57, v57, v129
    v_add_f32 v58, v58, v130
    v_add_f32 v59, v59, v131
    v_add_f32 v60, v60, v132
    v_add_f32 v61, v61, v133
    v_add_f32 v62, v62, v134
    v_add_f32 v63, v63, v135
    v_add_f32 v64, v64, v136
    v_add_f32 v65, v65, v137
    v_add_f32 v40, v40, v140
    v_add_f32 v41, v41, v141
    v_add_f32 v42, v42, v142
    v_add_f32 v43, v43, v143
    v_add_f32 v44, v44, v144
    v_add_f32 v45, v45, v145
    v_add_f32 v46, v46, v146
    v_add_f32 v47, v47, v147
    v_add_f32 v48, v48, v148
    v_add_f32 v49, v49, v149
    v_add_f32 v50, v50, v150
    v_add_f32 v51, v51, v151
    v_add_f32 v52, v52, v152
    v_add_f32 v53, v53, v153
    v_add_f32 v54, v54, v154
    v_add_f32 v55, v55, v155
    v_add_f32 v56, v56, v156
    v_add_f32 v57, v57, v157
    v_add_f32 v58, v58, v158
    v_add_f32 v59, v59, v159
    v_add_f32 v60, v60, v160
    v_add_f32 v61, v61, v161
    v_add_f32 v62, v62, v162
    v_add_f32 v63, v63, v163
    v_add_f32 v64, v64, v164
    v_add_f32 v65, v65, v165
    v_add_f32 v40, v40, v168
    v_add_f32 v41, v41, v169
    v_add_f32 v42, v42, v170
    v_add_f32 v43, v43, v171
    v_add_f32 v44, v44, v172
    v_add_f32 v45, v45, v173
    v_add_f32 v46, v46, v174
    v_add_f32 v47, v47, v175
    v_add_f32 v48, v48, v176
    v_add_f32 v49, v49, v177
    v_add_f32 v50, v50, v178
    v_add_f32 v51, v51, v179
    v_add_f32 v52, v52, v180
    v_add_f32 v53, v53, v181
    v_add_f32 v54, v54, v182
    v_add_f32 v55, v55, v183
    v_add_f32 v56, v56, v184
    v_add_f32 v57, v57, v185
    v_add_f32 v58, v58, v186
    v_add_f32 v59, v59, v187
    v_add_f32 v60, v60, v188
    v_add_f32 v61, v61, v189
    v_add_f32 v62, v62, v190
    v_add_f32 v63, v63, v191
    v_add_f32 v64, v64, v192
    v_add_f32 v65, v65, v193
    s_waitcnt vmcnt(0)
    v_lshlrev_b32 v108, 16, v108
    v_add_f32 v64, v64, v65
    v_sub_f32 v108, v108, v64
    s_lshl_b32 s32, s24, 2
    s_add_u32 s32, s32, s26
    s_mul_i32 s32, s32, 45056
    s_add_u32 s32, s32, 14417920
    s_mul_i32 s33, s25, 12
    s_add_u32 s33, s33, 80
    v_mul_u32_u24 v20, 3, v3
    v_add_u32 v20, s33, v20
    v_add_u32 v21, 0, v20
    v_lshlrev_b32 v21, 8, v21
    v_lshl_add_u32 v21, v2, 4, v21
    v_lshlrev_b32 v68, 16, v96
    v_and_b32 v69, s35, v96
    v_lshlrev_b32 v70, 16, v97
    v_and_b32 v71, s35, v97
    v_add_f32 v40, v40, v108
    v_add_f32 v41, v41, v108
    v_add_f32 v42, v42, v108
    v_add_f32 v43, v43, v108
    v_mul_f32 v40, v40, v68
    v_mul_f32 v41, v41, v69
    v_mul_f32 v42, v42, v70
    v_mul_f32 v43, v43, v71
    v_cvt_pk_bf16_f32 v112, v40, v41
    v_cvt_pk_bf16_f32 v113, v42, v43
    v_lshlrev_b32 v68, 16, v98
    v_and_b32 v69, s35, v98
    v_lshlrev_b32 v70, 16, v99
    v_and_b32 v71, s35, v99
    v_add_f32 v44, v44, v108
    v_add_f32 v45, v45, v108
    v_add_f32 v46, v46, v108
    v_add_f32 v47, v47, v108
    v_mul_f32 v44, v44, v68
    v_mul_f32 v45, v45, v69
    v_mul_f32 v46, v46, v70
    v_mul_f32 v47, v47, v71
    v_cvt_pk_bf16_f32 v114, v44, v45
    v_cvt_pk_bf16_f32 v115, v46, v47
    buffer_store_dwordx4 v[112:115], v21, s[20:23], s32 offen
    v_add_u32 v21, 1, v20
    v_lshlrev_b32 v21, 8, v21
    v_lshl_add_u32 v21, v2, 4, v21
    v_lshlrev_b32 v68, 16, v100
    v_and_b32 v69, s35, v100
    v_lshlrev_b32 v70, 16, v101
    v_and_b32 v71, s35, v101
    v_add_f32 v48, v48, v108
    v_add_f32 v49, v49, v108
    v_add_f32 v50, v50, v108
    v_add_f32 v51, v51, v108
    v_mul_f32 v48, v48, v68
    v_mul_f32 v49, v49, v69
    v_mul_f32 v50, v50, v70
    v_mul_f32 v51, v51, v71
    v_cvt_pk_bf16_f32 v116, v48, v49
    v_cvt_pk_bf16_f32 v117, v50, v51
    v_lshlrev_b32 v68, 16, v102
    v_and_b32 v69, s35, v102
    v_lshlrev_b32 v70, 16, v103
    v_and_b32 v71, s35, v103
    v_add_f32 v52, v52, v108
    v_add_f32 v53, v53, v108
    v_add_f32 v54, v54, v108
    v_add_f32 v55, v55, v108
    v_mul_f32 v52, v52, v68
    v_mul_f32 v53, v53, v69
    v_mul_f32 v54, v54, v70
    v_mul_f32 v55, v55, v71
    v_cvt_pk_bf16_f32 v118, v52, v53
    v_cvt_pk_bf16_f32 v119, v54, v55
    buffer_store_dwordx4 v[116:119], v21, s[20:23], s32 offen
    v_add_u32 v21, 2, v20
    v_lshlrev_b32 v21, 8, v21
    v_lshl_add_u32 v21, v2, 4, v21
    v_lshlrev_b32 v68, 16, v104
    v_and_b32 v69, s35, v104
    v_lshlrev_b32 v70, 16, v105
    v_and_b32 v71, s35, v105
    v_add_f32 v56, v56, v108
    v_add_f32 v57, v57, v108
    v_add_f32 v58, v58, v108
    v_add_f32 v59, v59, v108
    v_mul_f32 v56, v56, v68
    v_mul_f32 v57, v57, v69
    v_mul_f32 v58, v58, v70
    v_mul_f32 v59, v59, v71
    v_cvt_pk_bf16_f32 v120, v56, v57
    v_cvt_pk_bf16_f32 v121, v58, v59
    v_lshlrev_b32 v68, 16, v106
    v_and_b32 v69, s35, v106
    v_lshlrev_b32 v70, 16, v107
    v_and_b32 v71, s35, v107
    v_add_f32 v60, v60, v108
    v_add_f32 v61, v61, v108
    v_add_f32 v62, v62, v108
    v_add_f32 v63, v63, v108
    v_mul_f32 v60, v60, v68
    v_mul_f32 v61, v61, v69
    v_mul_f32 v62, v62, v70
    v_mul_f32 v63, v63, v71
    v_cvt_pk_bf16_f32 v122, v60, v61
    v_cvt_pk_bf16_f32 v123, v62, v63
    buffer_store_dwordx4 v[120:123], v21, s[20:23], s32 offen
    s_endpgm
K2_HELP:
    s_mov_b32 s35, 0xffff0000
    s_cmp_eq_u32 s26, 5
    s_cbranch_scc1 K2_HM
    s_cmp_eq_u32 s26, 6
    s_cbranch_scc1 K2_HW
    s_and_b32 s24, s2, 7
    s_lshr_b32 s25, s2, 3
    v_min_u32 v4, 19, v1
    v_mul_u32_u24 v5, 13108, v4
    v_lshrrev_b32 v5, 16, v5
    v_mul_u32_u24 v6, 5, v5
    v_sub_u32 v6, v4, v6
    v_mul_u32_u24 v5, 1680, v5
    v_lshl_add_u32 v5, v6, 4, v5
    s_mul_i32 s27, s24, 6720
    s_add_u32 s27, s27, 2623040
    buffer_load_dwordx4 v[8:11], v5, s[20:23], s27 offen
    s_add_u32 s27, s27, 53760
    buffer_load_dwordx4 v[12:15], v5, s[20:23], s27 offen
    s_add_u32 s27, s27, 53760
    buffer_load_dwordx4 v[16:19], v5, s[20:23], s27 offen
    s_add_u32 s27, s27, 53760
    buffer_load_dwordx4 v[20:23], v5, s[20:23], s27 offen
    s_add_u32 s27, s27, 53760
    buffer_load_dwordx4 v[24:27], v5, s[20:23], s27 offen
    s_add_u32 s27, s27, 53760
    buffer_load_dwordx4 v[28:31], v5, s[20:23], s27 offen
    s_add_u32 s27, s27, 53760
    buffer_load_dwordx4 v[32:35], v5, s[20:23], s27 offen
    s_add_u32 s27, s27, 53760
    buffer_load_dwordx4 v[36:39], v5, s[20:23], s27 offen
    s_add_u32 s27, s27, 53760
    buffer_load_dwordx4 v[40:43], v5, s[20:23], s27 offen
    s_add_u32 s27, s27, 53760
    buffer_load_dwordx4 v[44:47], v5, s[20:23], s27 offen
    s_add_u32 s27, s27, 53760
    buffer_load_dwordx4 v[48:51], v5, s[20:23], s27 offen
    s_add_u32 s27, s27, 53760
    buffer_load_dwordx4 v[52:55], v5, s[20:23], s27 offen
    s_add_u32 s27, s27, 53760
    buffer_load_dwordx4 v[56:59], v5, s[20:23], s27 offen
    s_add_u32 s27, s27, 53760
    buffer_load_dwordx4 v[60:63], v5, s[20:23], s27 offen
    s_add_u32 s27, s27, 53760
    buffer_load_dwordx4 v[64:67], v5, s[20:23], s27 offen
    s_add_u32 s27, s27, 53760
    buffer_load_dwordx4 v[68:71], v5, s[20:23], s27 offen
    s_add_u32 s27, s27, 53760
    s_lshl_b32 s27, s25, 6
    v_add_u32 v7, s27, v1
    v_mul_u32_u24 v4, 1280, v7
    s_mul_i32 s27, s24, 160
    buffer_load_dwordx4 v[136:139], v4, s[20:23], s27 offen offset:0
    buffer_load_dwordx4 v[140:143], v4, s[20:23], s27 offen offset:16
    buffer_load_dwordx4 v[144:147], v4, s[20:23], s27 offen offset:32
    buffer_load_dwordx4 v[148:151], v4, s[20:23], s27 offen offset:48
    buffer_load_dwordx4 v[152:155], v4, s[20:23], s27 offen offset:64
    buffer_load_dwordx4 v[156:159], v4, s[20:23], s27 offen offset:80
    buffer_load_dwordx4 v[160:163], v4, s[20:23], s27 offen offset:96
    buffer_load_dwordx4 v[164:167], v4, s[20:23], s27 offen offset:112
    buffer_load_dwordx4 v[168:171], v4, s[20:23], s27 offen offset:128
    buffer_load_dwordx4 v[172:175], v4, s[20:23], s27 offen offset:144
    s_waitcnt vmcnt(10)
    v_add_f32 v8, v8, v12
    v_add_f32 v9, v9, v13
    v_add_f32 v10, v10, v14
    v_add_f32 v11, v11, v15
    v_add_f32 v8, v8, v16
    v_add_f32 v9, v9, v17
    v_add_f32 v10, v10, v18
    v_add_f32 v11, v11, v19
    v_add_f32 v8, v8, v20
    v_add_f32 v9, v9, v21
    v_add_f32 v10, v10, v22
    v_add_f32 v11, v11, v23
    v_add_f32 v8, v8, v24
    v_add_f32 v9, v9, v25
    v_add_f32 v10, v10, v26
    v_add_f32 v11, v11, v27
    v_add_f32 v8, v8, v28
    v_add_f32 v9, v9, v29
    v_add_f32 v10, v10, v30
    v_add_f32 v11, v11, v31
    v_add_f32 v8, v8, v32
    v_add_f32 v9, v9, v33
    v_add_f32 v10, v10, v34
    v_add_f32 v11, v11, v35
    v_add_f32 v8, v8, v36
    v_add_f32 v9, v9, v37
    v_add_f32 v10, v10, v38
    v_add_f32 v11, v11, v39
    v_add_f32 v8, v8, v40
    v_add_f32 v9, v9, v41
    v_add_f32 v10, v10, v42
    v_add_f32 v11, v11, v43
    v_add_f32 v8, v8, v44
    v_add_f32 v9, v9, v45
    v_add_f32 v10, v10, v46
    v_add_f32 v11, v11, v47
    v_add_f32 v8, v8, v48
    v_add_f32 v9, v9, v49
    v_add_f32 v10, v10, v50
    v_add_f32 v11, v11, v51
    v_add_f32 v8, v8, v52
    v_add_f32 v9, v9, v53
    v_add_f32 v10, v10, v54
    v_add_f32 v11, v11, v55
    v_add_f32 v8, v8, v56
    v_add_f32 v9, v9, v57
    v_add_f32 v10, v10, v58
    v_add_f32 v11, v11, v59
    v_add_f32 v8, v8, v60
    v_add_f32 v9, v9, v61
    v_add_f32 v10, v10, v62
    v_add_f32 v11, v11, v63
    v_add_f32 v8, v8, v64
    v_add_f32 v9, v9, v65
    v_add_f32 v10, v10, v66
    v_add_f32 v11, v11, v67
    v_add_f32 v8, v8, v68
    v_add_f32 v9, v9, v69
    v_add_f32 v10, v10, v70
    v_add_f32 v11, v11, v71
    v_lshlrev_b32 v4, 4, v1
    v_add_u32 v4, 147456, v4
    v_cmp_gt_u32 vcc, 20, v1
    s_and_saveexec_b64 s[36:37], vcc
    ds_write_b128 v4, v[8:11]
    s_mov_b64 exec, s[36:37]
    s_waitcnt lgkmcnt(0)
    v_mov_b32 v4, 147456
    ds_read_b128 v[176:179], v4 offset:0
    ds_read_b128 v[180:183], v4 offset:16
    ds_read_b128 v[184:187], v4 offset:32
    ds_read_b128 v[188:191], v4 offset:48
    ds_read_b128 v[192:195], v4 offset:64
    ds_read_b128 v[196:199], v4 offset:80
    ds_read_b128 v[200:203], v4 offset:96
    ds_read_b128 v[204:207], v4 offset:112
    ds_read_b128 v[208:211], v4 offset:128
    ds_read_b128 v[212:215], v4 offset:144
    ds_read_b128 v[216:219], v4 offset:160
    ds_read_b128 v[220:223], v4 offset:176
    ds_read_b128 v[224:227], v4 offset:192
    ds_read_b128 v[228:231], v4 offset:208
    ds_read_b128 v[232:235], v4 offset:224
    ds_read_b128 v[236:239], v4 offset:240
    ds_read_b128 v[240:243], v4 offset:256
    ds_read_b128 v[244:247], v4 offset:272
    ds_read_b128 v[248:251], v4 offset:288
    ds_read_b128 v[252:255], v4 offset:304
    s_mov_b32 s39, 0x358637bd
    v_lshrrev_b32 v4, 4, v7
    v_mul_u32_u24 v4, 45056, v4
    v_lshl_add_u32 v4, v2, 4, v4
    s_mul_i32 s33, s24, 2560
    s_add_u32 s33, s33, 14417920
    s_waitcnt vmcnt(0) lgkmcnt(0)
    v_lshlrev_b32 v110, 16, v136
    v_and_b32 v111, s35, v136
    v_lshlrev_b32 v112, 16, v137
    v_and_b32 v113, s35, v137
    v_lshlrev_b32 v114, 16, v138
    v_and_b32 v115, s35, v138
    v_lshlrev_b32 v116, 16, v139
    v_and_b32 v117, s35, v139
    v_lshlrev_b32 v118, 16, v140
    v_and_b32 v119, s35, v140
    v_lshlrev_b32 v120, 16, v141
    v_and_b32 v121, s35, v141
    v_lshlrev_b32 v122, 16, v142
    v_and_b32 v123, s35, v142
    v_lshlrev_b32 v124, 16, v143
    v_and_b32 v125, s35, v143
    v_lshlrev_b32 v126, 16, v144
    v_and_b32 v127, s35, v144
    v_lshlrev_b32 v128, 16, v145
    v_and_b32 v129, s35, v145
    v_mul_f32 v130, v110, v176
    v_mul_f32 v131, v111, v177
    v_fmac_f32 v130, v112, v178
    v_fmac_f32 v131, v113, v179
    v_fmac_f32 v130, v114, v180
    v_fmac_f32 v131, v115, v181
    v_fmac_f32 v130, v116, v182
    v_fmac_f32 v131, v117, v183
    v_fmac_f32 v130, v118, v184
    v_fmac_f32 v131, v119, v185
    v_fmac_f32 v130, v120, v186
    v_fmac_f32 v131, v121, v187
    v_fmac_f32 v130, v122, v188
    v_fmac_f32 v131, v123, v189
    v_fmac_f32 v130, v124, v190
    v_fmac_f32 v131, v125, v191
    v_fmac_f32 v130, v126, v192
    v_fmac_f32 v131, v127, v193
    v_fmac_f32 v130, v128, v194
    v_fmac_f32 v131, v129, v195
    v_add_f32 v130, v130, v131
    v_add_f32 v130, s39, v130
    v_rcp_f32 v130, v130
    s_nop 0
    v_mul_f32 v110, v110, v130
    v_mul_f32 v111, v111, v130
    v_mul_f32 v112, v112, v130
    v_mul_f32 v113, v113, v130
    v_mul_f32 v114, v114, v130
    v_mul_f32 v115, v115, v130
    v_mul_f32 v116, v116, v130
    v_mul_f32 v117, v117, v130
    v_mul_f32 v118, v118, v130
    v_mul_f32 v119, v119, v130
    v_mul_f32 v120, v120, v130
    v_mul_f32 v121, v121, v130
    v_mul_f32 v122, v122, v130
    v_mul_f32 v123, v123, v130
    v_mul_f32 v124, v124, v130
    v_mul_f32 v125, v125, v130
    v_mul_f32 v126, v126, v130
    v_mul_f32 v127, v127, v130
    v_mul_f32 v128, v128, v130
    v_mul_f32 v129, v129, v130
    v_cvt_pk_bf16_f32 v136, v110, v111
    v_cvt_pk_bf16_f32 v137, v112, v113
    v_cvt_pk_bf16_f32 v138, v114, v115
    v_cvt_pk_bf16_f32 v139, v116, v117
    v_cvt_pk_bf16_f32 v140, v118, v119
    v_cvt_pk_bf16_f32 v141, v120, v121
    v_cvt_pk_bf16_f32 v142, v122, v123
    v_cvt_pk_bf16_f32 v143, v124, v125
    v_cvt_pk_bf16_f32 v144, v126, v127
    v_cvt_pk_bf16_f32 v145, v128, v129
    v_lshlrev_b32 v110, 16, v146
    v_and_b32 v111, s35, v146
    v_lshlrev_b32 v112, 16, v147
    v_and_b32 v113, s35, v147
    v_lshlrev_b32 v114, 16, v148
    v_and_b32 v115, s35, v148
    v_lshlrev_b32 v116, 16, v149
    v_and_b32 v117, s35, v149
    v_lshlrev_b32 v118, 16, v150
    v_and_b32 v119, s35, v150
    v_lshlrev_b32 v120, 16, v151
    v_and_b32 v121, s35, v151
    v_lshlrev_b32 v122, 16, v152
    v_and_b32 v123, s35, v152
    v_lshlrev_b32 v124, 16, v153
    v_and_b32 v125, s35, v153
    v_lshlrev_b32 v126, 16, v154
    v_and_b32 v127, s35, v154
    v_lshlrev_b32 v128, 16, v155
    v_and_b32 v129, s35, v155
    v_mul_f32 v130, v110, v196
    v_mul_f32 v131, v111, v197
    v_fmac_f32 v130, v112, v198
    v_fmac_f32 v131, v113, v199
    v_fmac_f32 v130, v114, v200
    v_fmac_f32 v131, v115, v201
    v_fmac_f32 v130, v116, v202
    v_fmac_f32 v131, v117, v203
    v_fmac_f32 v130, v118, v204
    v_fmac_f32 v131, v119, v205
    v_fmac_f32 v130, v120, v206
    v_fmac_f32 v131, v121, v207
    v_fmac_f32 v130, v122, v208
    v_fmac_f32 v131, v123, v209
    v_fmac_f32 v130, v124, v210
    v_fmac_f32 v131, v125, v211
    v_fmac_f32 v130, v126, v212
    v_fmac_f32 v131, v127, v213
    v_fmac_f32 v130, v128, v214
    v_fmac_f32 v131, v129, v215
    v_add_f32 v130, v130, v131
    v_add_f32 v130, s39, v130
    v_rcp_f32 v130, v130
    s_nop 0
    v_mul_f32 v110, v110, v130
    v_mul_f32 v111, v111, v130
    v_mul_f32 v112, v112, v130
    v_mul_f32 v113, v113, v130
    v_mul_f32 v114, v114, v130
    v_mul_f32 v115, v115, v130
    v_mul_f32 v116, v116, v130
    v_mul_f32 v117, v117, v130
    v_mul_f32 v118, v118, v130
    v_mul_f32 v119, v119, v130
    v_mul_f32 v120, v120, v130
    v_mul_f32 v121, v121, v130
    v_mul_f32 v122, v122, v130
    v_mul_f32 v123, v123, v130
    v_mul_f32 v124, v124, v130
    v_mul_f32 v125, v125, v130
    v_mul_f32 v126, v126, v130
    v_mul_f32 v127, v127, v130
    v_mul_f32 v128, v128, v130
    v_mul_f32 v129, v129, v130
    v_cvt_pk_bf16_f32 v146, v110, v111
    v_cvt_pk_bf16_f32 v147, v112, v113
    v_cvt_pk_bf16_f32 v148, v114, v115
    v_cvt_pk_bf16_f32 v149, v116, v117
    v_cvt_pk_bf16_f32 v150, v118, v119
    v_cvt_pk_bf16_f32 v151, v120, v121
    v_cvt_pk_bf16_f32 v152, v122, v123
    v_cvt_pk_bf16_f32 v153, v124, v125
    v_cvt_pk_bf16_f32 v154, v126, v127
    v_cvt_pk_bf16_f32 v155, v128, v129
    v_lshlrev_b32 v110, 16, v156
    v_and_b32 v111, s35, v156
    v_lshlrev_b32 v112, 16, v157
    v_and_b32 v113, s35, v157
    v_lshlrev_b32 v114, 16, v158
    v_and_b32 v115, s35, v158
    v_lshlrev_b32 v116, 16, v159
    v_and_b32 v117, s35, v159
    v_lshlrev_b32 v118, 16, v160
    v_and_b32 v119, s35, v160
    v_lshlrev_b32 v120, 16, v161
    v_and_b32 v121, s35, v161
    v_lshlrev_b32 v122, 16, v162
    v_and_b32 v123, s35, v162
    v_lshlrev_b32 v124, 16, v163
    v_and_b32 v125, s35, v163
    v_lshlrev_b32 v126, 16, v164
    v_and_b32 v127, s35, v164
    v_lshlrev_b32 v128, 16, v165
    v_and_b32 v129, s35, v165
    v_mul_f32 v130, v110, v216
    v_mul_f32 v131, v111, v217
    v_fmac_f32 v130, v112, v218
    v_fmac_f32 v131, v113, v219
    v_fmac_f32 v130, v114, v220
    v_fmac_f32 v131, v115, v221
    v_fmac_f32 v130, v116, v222
    v_fmac_f32 v131, v117, v223
    v_fmac_f32 v130, v118, v224
    v_fmac_f32 v131, v119, v225
    v_fmac_f32 v130, v120, v226
    v_fmac_f32 v131, v121, v227
    v_fmac_f32 v130, v122, v228
    v_fmac_f32 v131, v123, v229
    v_fmac_f32 v130, v124, v230
    v_fmac_f32 v131, v125, v231
    v_fmac_f32 v130, v126, v232
    v_fmac_f32 v131, v127, v233
    v_fmac_f32 v130, v128, v234
    v_fmac_f32 v131, v129, v235
    v_add_f32 v130, v130, v131
    v_add_f32 v130, s39, v130
    v_rcp_f32 v130, v130
    s_nop 0
    v_mul_f32 v110, v110, v130
    v_mul_f32 v111, v111, v130
    v_mul_f32 v112, v112, v130
    v_mul_f32 v113, v113, v130
    v_mul_f32 v114, v114, v130
    v_mul_f32 v115, v115, v130
    v_mul_f32 v116, v116, v130
    v_mul_f32 v117, v117, v130
    v_mul_f32 v118, v118, v130
    v_mul_f32 v119, v119, v130
    v_mul_f32 v120, v120, v130
    v_mul_f32 v121, v121, v130
    v_mul_f32 v122, v122, v130
    v_mul_f32 v123, v123, v130
    v_mul_f32 v124, v124, v130
    v_mul_f32 v125, v125, v130
    v_mul_f32 v126, v126, v130
    v_mul_f32 v127, v127, v130
    v_mul_f32 v128, v128, v130
    v_mul_f32 v129, v129, v130
    v_cvt_pk_bf16_f32 v156, v110, v111
    v_cvt_pk_bf16_f32 v157, v112, v113
    v_cvt_pk_bf16_f32 v158, v114, v115
    v_cvt_pk_bf16_f32 v159, v116, v117
    v_cvt_pk_bf16_f32 v160, v118, v119
    v_cvt_pk_bf16_f32 v161, v120, v121
    v_cvt_pk_bf16_f32 v162, v122, v123
    v_cvt_pk_bf16_f32 v163, v124, v125
    v_cvt_pk_bf16_f32 v164, v126, v127
    v_cvt_pk_bf16_f32 v165, v128, v129
    v_lshlrev_b32 v110, 16, v166
    v_and_b32 v111, s35, v166
    v_lshlrev_b32 v112, 16, v167
    v_and_b32 v113, s35, v167
    v_lshlrev_b32 v114, 16, v168
    v_and_b32 v115, s35, v168
    v_lshlrev_b32 v116, 16, v169
    v_and_b32 v117, s35, v169
    v_lshlrev_b32 v118, 16, v170
    v_and_b32 v119, s35, v170
    v_lshlrev_b32 v120, 16, v171
    v_and_b32 v121, s35, v171
    v_lshlrev_b32 v122, 16, v172
    v_and_b32 v123, s35, v172
    v_lshlrev_b32 v124, 16, v173
    v_and_b32 v125, s35, v173
    v_lshlrev_b32 v126, 16, v174
    v_and_b32 v127, s35, v174
    v_lshlrev_b32 v128, 16, v175
    v_and_b32 v129, s35, v175
    v_mul_f32 v130, v110, v236
    v_mul_f32 v131, v111, v237
    v_fmac_f32 v130, v112, v238
    v_fmac_f32 v131, v113, v239
    v_fmac_f32 v130, v114, v240
    v_fmac_f32 v131, v115, v241
    v_fmac_f32 v130, v116, v242
    v_fmac_f32 v131, v117, v243
    v_fmac_f32 v130, v118, v244
    v_fmac_f32 v131, v119, v245
    v_fmac_f32 v130, v120, v246
    v_fmac_f32 v131, v121, v247
    v_fmac_f32 v130, v122, v248
    v_fmac_f32 v131, v123, v249
    v_fmac_f32 v130, v124, v250
    v_fmac_f32 v131, v125, v251
    v_fmac_f32 v130, v126, v252
    v_fmac_f32 v131, v127, v253
    v_fmac_f32 v130, v128, v254
    v_fmac_f32 v131, v129, v255
    v_add_f32 v130, v130, v131
    v_add_f32 v130, s39, v130
    v_rcp_f32 v130, v130
    s_nop 0
    v_mul_f32 v110, v110, v130
    v_mul_f32 v111, v111, v130
    v_mul_f32 v112, v112, v130
    v_mul_f32 v113, v113, v130
    v_mul_f32 v114, v114, v130
    v_mul_f32 v115, v115, v130
    v_mul_f32 v116, v116, v130
    v_mul_f32 v117, v117, v130
    v_mul_f32 v118, v118, v130
    v_mul_f32 v119, v119, v130
    v_mul_f32 v120, v120, v130
    v_mul_f32 v121, v121, v130
    v_mul_f32 v122, v122, v130
    v_mul_f32 v123, v123, v130
    v_mul_f32 v124, v124, v130
    v_mul_f32 v125, v125, v130
    v_mul_f32 v126, v126, v130
    v_mul_f32 v127, v127, v130
    v_mul_f32 v128, v128, v130
    v_mul_f32 v129, v129, v130
    v_cvt_pk_bf16_f32 v166, v110, v111
    v_cvt_pk_bf16_f32 v167, v112, v113
    v_cvt_pk_bf16_f32 v168, v114, v115
    v_cvt_pk_bf16_f32 v169, v116, v117
    v_cvt_pk_bf16_f32 v170, v118, v119
    v_cvt_pk_bf16_f32 v171, v120, v121
    v_cvt_pk_bf16_f32 v172, v122, v123
    v_cvt_pk_bf16_f32 v173, v124, v125
    v_cvt_pk_bf16_f32 v174, v126, v127
    v_cvt_pk_bf16_f32 v175, v128, v129
    buffer_store_dwordx4 v[136:139], v4, s[20:23], s33 offen offset:0
    buffer_store_dwordx4 v[140:143], v4, s[20:23], s33 offen offset:256
    buffer_store_dwordx4 v[144:147], v4, s[20:23], s33 offen offset:512
    buffer_store_dwordx4 v[148:151], v4, s[20:23], s33 offen offset:768
    buffer_store_dwordx4 v[152:155], v4, s[20:23], s33 offen offset:1024
    buffer_store_dwordx4 v[156:159], v4, s[20:23], s33 offen offset:1280
    buffer_store_dwordx4 v[160:163], v4, s[20:23], s33 offen offset:1536
    buffer_store_dwordx4 v[164:167], v4, s[20:23], s33 offen offset:1792
    buffer_store_dwordx4 v[168:171], v4, s[20:23], s33 offen offset:2048
    buffer_store_dwordx4 v[172:175], v4, s[20:23], s33 offen offset:2304
    s_endpgm
K2_HM:
    s_mov_b32 s12, s8
    s_and_b32 s13, s9, 0xffff
    s_mov_b32 s14, 819200
    s_mov_b32 s15, 0x00020000
    s_and_b32 s28, s2, 31
    s_lshr_b32 s29, s2, 5
    s_mul_i32 s32, s28, 25600
    s_mul_i32 s33, s29, 160
    s_add_u32 s32, s32, s33
    v_add_u32 v4, 0, v1
    v_mul_u32_u24 v5, 6554, v4
    v_lshrrev_b32 v5, 16, v5
    v_mul_u32_u24 v6, 10, v5
    v_sub_u32 v6, v4, v6
    v_mul_u32_u24 v5, 1280, v5
    v_lshl_add_u32 v5, v6, 4, v5
    s_mov_b32 m0, 151552
    s_nop 0
    buffer_load_dwordx4 v5, s[12:15], s32 offen lds
    v_add_u32 v4, 64, v1
    v_mul_u32_u24 v5, 6554, v4
    v_lshrrev_b32 v5, 16, v5
    v_mul_u32_u24 v6, 10, v5
    v_sub_u32 v6, v4, v6
    v_mul_u32_u24 v5, 1280, v5
    v_lshl_add_u32 v5, v6, 4, v5
    s_mov_b32 m0, 152576
    s_nop 0
    buffer_load_dwordx4 v5, s[12:15], s32 offen lds
    v_add_u32 v4, 128, v1
    v_mul_u32_u24 v5, 6554, v4
    v_lshrrev_b32 v5, 16, v5
    v_mul_u32_u24 v6, 10, v5
    v_sub_u32 v6, v4, v6
    v_mul_u32_u24 v5, 1280, v5
    v_lshl_add_u32 v5, v6, 4, v5
    s_mov_b32 m0, 153600
    s_nop 0
    buffer_load_dwordx4 v5, s[12:15], s32 offen lds
    v_add_u32 v4, 192, v1
    v_mul_u32_u24 v5, 6554, v4
    v_lshrrev_b32 v5, 16, v5
    v_mul_u32_u24 v6, 10, v5
    v_sub_u32 v6, v4, v6
    v_mul_u32_u24 v5, 1280, v5
    v_lshl_add_u32 v5, v6, 4, v5
    s_mov_b32 m0, 154624
    s_nop 0
    buffer_load_dwordx4 v5, s[12:15], s32 offen lds
    v_add_u32 v4, 256, v1
    v_mul_u32_u24 v5, 6554, v4
    v_lshrrev_b32 v5, 16, v5
    v_mul_u32_u24 v6, 10, v5
    v_sub_u32 v6, v4, v6
    v_mul_u32_u24 v5, 1280, v5
    v_lshl_add_u32 v5, v6, 4, v5
    s_mov_b32 m0, 155648
    s_nop 0
    buffer_load_dwordx4 v5, s[12:15], s32 offen lds
    v_lshlrev_b32 v5, 4, v1
    v_add_u32 v6, 1024, v5
    v_min_u32 v6, 1584, v6
    s_mul_i32 s27, s28, 1680
    s_add_u32 s27, s27, 2621440
    buffer_load_dwordx4 v[8:11], v5, s[20:23], s27 offen
    buffer_load_dwordx4 v[72:75], v6, s[20:23], s27 offen
    s_add_u32 s27, s27, 53760
    buffer_load_dwordx4 v[12:15], v5, s[20:23], s27 offen
    buffer_load_dwordx4 v[76:79], v6, s[20:23], s27 offen
    s_add_u32 s27, s27, 53760
    buffer_load_dwordx4 v[16:19], v5, s[20:23], s27 offen
    buffer_load_dwordx4 v[80:83], v6, s[20:23], s27 offen
    s_add_u32 s27, s27, 53760
    buffer_load_dwordx4 v[20:23], v5, s[20:23], s27 offen
    buffer_load_dwordx4 v[84:87], v6, s[20:23], s27 offen
    s_add_u32 s27, s27, 53760
    buffer_load_dwordx4 v[24:27], v5, s[20:23], s27 offen
    buffer_load_dwordx4 v[88:91], v6, s[20:23], s27 offen
    s_add_u32 s27, s27, 53760
    buffer_load_dwordx4 v[28:31], v5, s[20:23], s27 offen
    buffer_load_dwordx4 v[92:95], v6, s[20:23], s27 offen
    s_add_u32 s27, s27, 53760
    buffer_load_dwordx4 v[32:35], v5, s[20:23], s27 offen
    buffer_load_dwordx4 v[96:99], v6, s[20:23], s27 offen
    s_add_u32 s27, s27, 53760
    buffer_load_dwordx4 v[36:39], v5, s[20:23], s27 offen
    buffer_load_dwordx4 v[100:103], v6, s[20:23], s27 offen
    s_add_u32 s27, s27, 53760
    buffer_load_dwordx4 v[40:43], v5, s[20:23], s27 offen
    buffer_load_dwordx4 v[104:107], v6, s[20:23], s27 offen
    s_add_u32 s27, s27, 53760
    buffer_load_dwordx4 v[44:47], v5, s[20:23], s27 offen
    buffer_load_dwordx4 v[108:111], v6, s[20:23], s27 offen
    s_add_u32 s27, s27, 53760
    buffer_load_dwordx4 v[48:51], v5, s[20:23], s27 offen
    buffer_load_dwordx4 v[112:115], v6, s[20:23], s27 offen
    s_add_u32 s27, s27, 53760
    buffer_load_dwordx4 v[52:55], v5, s[20:23], s27 offen
    buffer_load_dwordx4 v[116:119], v6, s[20:23], s27 offen
    s_add_u32 s27, s27, 53760
    buffer_load_dwordx4 v[56:59], v5, s[20:23], s27 offen
    buffer_load_dwordx4 v[120:123], v6, s[20:23], s27 offen
    s_add_u32 s27, s27, 53760
    buffer_load_dwordx4 v[60:63], v5, s[20:23], s27 offen
    buffer_load_dwordx4 v[124:127], v6, s[20:23], s27 offen
    s_add_u32 s27, s27, 53760
    buffer_load_dwordx4 v[64:67], v5, s[20:23], s27 offen
    buffer_load_dwordx4 v[128:131], v6, s[20:23], s27 offen
    s_add_u32 s27, s27, 53760
    buffer_load_dwordx4 v[68:71], v5, s[20:23], s27 offen
    buffer_load_dwordx4 v[132:135], v6, s[20:23], s27 offen
    s_add_u32 s27, s27, 53760
    v_mov_b32 v140, 0
    v_mov_b32 v141, 0
    v_mov_b32 v142, 0
    v_mov_b32 v143, 0
    v_add_u32 v7, 150080, v5
    v_cmp_gt_u32 vcc, 60, v1
    s_and_saveexec_b64 s[36:37], vcc
    ds_write_b128 v7, v[140:143]
    s_mov_b64 exec, s[36:37]
    v_mul_u32_u24 v136, 640, v3
    v_lshl_add_u32 v136, v2, 2, v136
    v_add_u32 v136, 148480, v136
    v_bfe_u32 v137, v1, 2, 2
    v_lshl_add_u32 v137, v3, 3, v137
    v_mul_u32_u24 v137, 160, v137
    v_and_b32 v138, 3, v1
    v_mul_u32_u24 v138, 40, v138
    v_add_u32 v137, v137, v138
    v_add_u32 v137, 151552, v137
    s_waitcnt vmcnt(0)
    v_add_f32 v8, v8, v12
    v_add_f32 v9, v9, v13
    v_add_f32 v10, v10, v14
    v_add_f32 v11, v11, v15
    v_add_f32 v72, v72, v76
    v_add_f32 v73, v73, v77
    v_add_f32 v74, v74, v78
    v_add_f32 v75, v75, v79
    v_add_f32 v8, v8, v16
    v_add_f32 v9, v9, v17
    v_add_f32 v10, v10, v18
    v_add_f32 v11, v11, v19
    v_add_f32 v72, v72, v80
    v_add_f32 v73, v73, v81
    v_add_f32 v74, v74, v82
    v_add_f32 v75, v75, v83
    v_add_f32 v8, v8, v20
    v_add_f32 v9, v9, v21
    v_add_f32 v10, v10, v22
    v_add_f32 v11, v11, v23
    v_add_f32 v72, v72, v84
    v_add_f32 v73, v73, v85
    v_add_f32 v74, v74, v86
    v_add_f32 v75, v75, v87
    v_add_f32 v8, v8, v24
    v_add_f32 v9, v9, v25
    v_add_f32 v10, v10, v26
    v_add_f32 v11, v11, v27
    v_add_f32 v72, v72, v88
    v_add_f32 v73, v73, v89
    v_add_f32 v74, v74, v90
    v_add_f32 v75, v75, v91
    v_add_f32 v8, v8, v28
    v_add_f32 v9, v9, v29
    v_add_f32 v10, v10, v30
    v_add_f32 v11, v11, v31
    v_add_f32 v72, v72, v92
    v_add_f32 v73, v73, v93
    v_add_f32 v74, v74, v94
    v_add_f32 v75, v75, v95
    v_add_f32 v8, v8, v32
    v_add_f32 v9, v9, v33
    v_add_f32 v10, v10, v34
    v_add_f32 v11, v11, v35
    v_add_f32 v72, v72, v96
    v_add_f32 v73, v73, v97
    v_add_f32 v74, v74, v98
    v_add_f32 v75, v75, v99
    v_add_f32 v8, v8, v36
    v_add_f32 v9, v9, v37
    v_add_f32 v10, v10, v38
    v_add_f32 v11, v11, v39
    v_add_f32 v72, v72, v100
    v_add_f32 v73, v73, v101
    v_add_f32 v74, v74, v102
    v_add_f32 v75, v75, v103
    v_add_f32 v8, v8, v40
    v_add_f32 v9, v9, v41
    v_add_f32 v10, v10, v42
    v_add_f32 v11, v11, v43
    v_add_f32 v72, v72, v104
    v_add_f32 v73, v73, v105
    v_add_f32 v74, v74, v106
    v_add_f32 v75, v75, v107
    v_add_f32 v8, v8, v44
    v_add_f32 v9, v9, v45
    v_add_f32 v10, v10, v46
    v_add_f32 v11, v11, v47
    v_add_f32 v72, v72, v108
    v_add_f32 v73, v73, v109
    v_add_f32 v74, v74, v110
    v_add_f32 v75, v75, v111
    v_add_f32 v8, v8, v48
    v_add_f32 v9, v9, v49
    v_add_f32 v10, v10, v50
    v_add_f32 v11, v11, v51
    v_add_f32 v72, v72, v112
    v_add_f32 v73, v73, v113
    v_add_f32 v74, v74, v114
    v_add_f32 v75, v75, v115
    v_add_f32 v8, v8, v52
    v_add_f32 v9, v9, v53
    v_add_f32 v10, v10, v54
    v_add_f32 v11, v11, v55
    v_add_f32 v72, v72, v116
    v_add_f32 v73, v73, v117
    v_add_f32 v74, v74, v118
    v_add_f32 v75, v75, v119
    v_add_f32 v8, v8, v56
    v_add_f32 v9, v9, v57
    v_add_f32 v10, v10, v58
    v_add_f32 v11, v11, v59
    v_add_f32 v72, v72, v120
    v_add_f32 v73, v73, v121
    v_add_f32 v74, v74, v122
    v_add_f32 v75, v75, v123
    v_add_f32 v8, v8, v60
    v_add_f32 v9, v9, v61
    v_add_f32 v10, v10, v62
    v_add_f32 v11, v11, v63
    v_add_f32 v72, v72, v124
    v_add_f32 v73, v73, v125
    v_add_f32 v74, v74, v126
    v_add_f32 v75, v75, v127
    v_add_f32 v8, v8, v64
    v_add_f32 v9, v9, v65
    v_add_f32 v10, v10, v66
    v_add_f32 v11, v11, v67
    v_add_f32 v72, v72, v128
    v_add_f32 v73, v73, v129
    v_add_f32 v74, v74, v130
    v_add_f32 v75, v75, v131
    v_add_f32 v8, v8, v68
    v_add_f32 v9, v9, v69
    v_add_f32 v10, v10, v70
    v_add_f32 v11, v11, v71
    v_add_f32 v72, v72, v132
    v_add_f32 v73, v73, v133
    v_add_f32 v74, v74, v134
    v_add_f32 v75, v75, v135
    v_add_u32 v5, 148480, v5
    v_add_u32 v6, 148480, v6
    ds_write_b128 v5, v[8:11]
    ds_write_b128 v6, v[72:75]
    ds_read_b64_tr_b16 v[160:161], v137 offset:0
    ds_read_b64_tr_b16 v[162:163], v137 offset:640
    ds_read_b64_tr_b16 v[164:165], v137 offset:8
    ds_read_b64_tr_b16 v[166:167], v137 offset:648
    ds_read_b64_tr_b16 v[168:169], v137 offset:16
    ds_read_b64_tr_b16 v[170:171], v137 offset:656
    ds_read_b64_tr_b16 v[172:173], v137 offset:24
    ds_read_b64_tr_b16 v[174:175], v137 offset:664
    ds_read_b64_tr_b16 v[176:177], v137 offset:32
    ds_read_b64_tr_b16 v[178:179], v137 offset:672
    s_waitcnt lgkmcnt(0)
    ds_read_b32 v8, v136 offset:0
    ds_read_b32 v9, v136 offset:80
    ds_read_b32 v10, v136 offset:160
    ds_read_b32 v11, v136 offset:240
    ds_read_b32 v12, v136 offset:320
    ds_read_b32 v13, v136 offset:400
    ds_read_b32 v14, v136 offset:480
    ds_read_b32 v15, v136 offset:560
    ds_read_b32 v16, v136 offset:64
    ds_read_b32 v17, v136 offset:144
    ds_read_b32 v18, v136 offset:224
    ds_read_b32 v19, v136 offset:304
    ds_read_b32 v20, v136 offset:384
    ds_read_b32 v21, v136 offset:464
    ds_read_b32 v22, v136 offset:544
    ds_read_b32 v23, v136 offset:624
    s_mul_i32 s33, s28, 20
    s_mul_i32 s34, s29, 225280
    s_add_u32 s34, s34, 20185088
    v_lshlrev_b32 v30, 2, v3
    v_add_u32 v30, s33, v30
    v_lshrrev_b32 v31, 5, v30
    v_mul_u32_u24 v31, 5120, v31
    v_bfe_u32 v32, v30, 3, 2
    v_lshl_add_u32 v31, v32, 8, v31
    v_and_b32 v32, 7, v30
    v_lshl_add_u32 v31, v32, 1, v31
    v_lshl_add_u32 v34, v2, 4, v31
    v_lshlrev_b32 v30, 2, v3
    v_add_u32 v30, s33, v30
    v_add_u32 v30, 16, v30
    v_lshrrev_b32 v31, 5, v30
    v_mul_u32_u24 v31, 5120, v31
    v_bfe_u32 v32, v30, 3, 2
    v_lshl_add_u32 v31, v32, 8, v31
    v_and_b32 v32, 7, v30
    v_lshl_add_u32 v31, v32, 1, v31
    v_lshl_add_u32 v35, v2, 4, v31
    s_waitcnt lgkmcnt(0)
    v_cvt_pk_bf16_f32 v40, v8, v9
    v_cvt_pk_bf16_f32 v41, v10, v11
    v_cvt_pk_bf16_f32 v42, v12, v13
    v_cvt_pk_bf16_f32 v43, v14, v15
    v_cvt_pk_bf16_f32 v44, v16, v17
    v_cvt_pk_bf16_f32 v45, v18, v19
    v_cvt_pk_bf16_f32 v46, v20, v21
    v_cvt_pk_bf16_f32 v47, v22, v23
    s_nop 1
    v_mfma_f32_16x16x32_bf16 v[48:51], v[40:43], v[160:163], 0
    v_mfma_f32_16x16x32_bf16 v[52:55], v[40:43], v[164:167], 0
    v_mfma_f32_16x16x32_bf16 v[56:59], v[40:43], v[168:171], 0
    v_mfma_f32_16x16x32_bf16 v[60:63], v[40:43], v[172:175], 0
    v_mfma_f32_16x16x32_bf16 v[64:67], v[40:43], v[176:179], 0
    v_mfma_f32_16x16x32_bf16 v[68:71], v[44:47], v[160:163], 0
    v_mfma_f32_16x16x32_bf16 v[72:75], v[44:47], v[164:167], 0
    v_mfma_f32_16x16x32_bf16 v[76:79], v[44:47], v[168:171], 0
    v_mfma_f32_16x16x32_bf16 v[80:83], v[44:47], v[172:175], 0
    v_mfma_f32_16x16x32_bf16 v[84:87], v[44:47], v[176:179], 0
    s_nop 7
    v_cmp_eq_u32 s[36:37], 0, v3
    v_cvt_pk_bf16_f32 v48, v48, v49
    v_cvt_pk_bf16_f32 v49, v50, v51
    buffer_store_dwordx2 v[48:49], v34, s[20:23], s34 offen offset:0
    v_cvt_pk_bf16_f32 v52, v52, v53
    v_cvt_pk_bf16_f32 v53, v54, v55
    buffer_store_dwordx2 v[52:53], v34, s[20:23], s34 offen offset:1024
    v_cvt_pk_bf16_f32 v56, v56, v57
    v_cvt_pk_bf16_f32 v57, v58, v59
    buffer_store_dwordx2 v[56:57], v34, s[20:23], s34 offen offset:2048
    v_cvt_pk_bf16_f32 v60, v60, v61
    v_cvt_pk_bf16_f32 v61, v62, v63
    buffer_store_dwordx2 v[60:61], v34, s[20:23], s34 offen offset:3072
    v_cvt_pk_bf16_f32 v64, v64, v65
    v_cvt_pk_bf16_f32 v65, v66, v67
    s_add_u32 s38, s34, 4096
    buffer_store_dwordx2 v[64:65], v34, s[20:23], s38 offen
    s_mov_b64 exec, s[36:37]
    v_cvt_pk_bf16_f32 v68, v68, v69
    v_cvt_pk_bf16_f32 v69, v70, v71
    buffer_store_dwordx2 v[68:69], v35, s[20:23], s34 offen offset:0
    v_cvt_pk_bf16_f32 v72, v72, v73
    v_cvt_pk_bf16_f32 v73, v74, v75
    buffer_store_dwordx2 v[72:73], v35, s[20:23], s34 offen offset:1024
    v_cvt_pk_bf16_f32 v76, v76, v77
    v_cvt_pk_bf16_f32 v77, v78, v79
    buffer_store_dwordx2 v[76:77], v35, s[20:23], s34 offen offset:2048
    v_cvt_pk_bf16_f32 v80, v80, v81
    v_cvt_pk_bf16_f32 v81, v82, v83
    buffer_store_dwordx2 v[80:81], v35, s[20:23], s34 offen offset:3072
    v_cvt_pk_bf16_f32 v84, v84, v85
    v_cvt_pk_bf16_f32 v85, v86, v87
    s_add_u32 s38, s34, 4096
    buffer_store_dwordx2 v[84:85], v35, s[20:23], s38 offen
    s_mov_b64 exec, -1
    s_endpgm
K2_HW:
    s_mov_b32 s16, s40
    s_and_b32 s17, s41, 0xffff
    s_mov_b32 s18, 983040
    s_mov_b32 s19, 0x00020000
    s_mul_i32 s33, s2, 60
    v_add_u32 v110, s33, v1
    v_mul_u32_u24 v111, 6554, v110
    v_lshrrev_b32 v111, 20, v111
    v_mul_u32_u24 v112, 160, v111
    v_sub_u32 v112, v110, v112
    v_mul_u32_u24 v113, 10240, v111
    v_lshl_add_u32 v113, v112, 3, v113
    buffer_load_dwordx2 v[136:137], v113, s[16:19], 0 offen offset:0
    buffer_load_dwordx2 v[138:139], v113, s[16:19], 0 offen offset:1280
    buffer_load_dwordx2 v[140:141], v113, s[16:19], 0 offen offset:2560
    buffer_load_dwordx2 v[142:143], v113, s[16:19], 0 offen offset:3840
    s_movk_i32 s34, 5120
    buffer_load_dwordx2 v[144:145], v113, s[16:19], s34 offen
    s_movk_i32 s34, 6400
    buffer_load_dwordx2 v[146:147], v113, s[16:19], s34 offen
    s_movk_i32 s34, 7680
    buffer_load_dwordx2 v[148:149], v113, s[16:19], s34 offen
    s_movk_i32 s34, 8960
    buffer_load_dwordx2 v[150:151], v113, s[16:19], s34 offen
    s_mov_b32 s30, 0x05040100
    s_mov_b32 s31, 0x07060302
    s_mov_b32 s32, 20185088
    v_mul_u32_u24 v8, 3277, v112
    v_lshrrev_b32 v8, 16, v8
    v_mul_u32_u24 v9, 20, v8
    v_sub_u32 v9, v112, v9
    v_mul_u32_u24 v10, 52, v9
    v_lshrrev_b32 v10, 8, v10
    v_mul_u32_u24 v11, 5, v10
    v_sub_u32 v11, v9, v11
    v_add_u32 v111, 80, v111
    v_lshrrev_b32 v12, 2, v111
    v_and_b32 v13, 3, v111
    v_mul_u32_u24 v8, 44, v8
    v_add_u32 v8, v8, v12
    v_mul_u32_u24 v8, 5, v8
    v_add_u32 v8, v8, v11
    v_lshlrev_b32 v8, 10, v8
    v_lshl_add_u32 v8, v13, 8, v8
    v_lshl_add_u32 v8, v10, 6, v8
    s_waitcnt vmcnt(0)
    v_perm_b32 v152, v138, v136, s30
    v_perm_b32 v153, v142, v140, s30
    v_perm_b32 v154, v146, v144, s30
    v_perm_b32 v155, v150, v148, s30
    v_perm_b32 v156, v138, v136, s31
    v_perm_b32 v157, v142, v140, s31
    v_perm_b32 v158, v146, v144, s31
    v_perm_b32 v159, v150, v148, s31
    v_perm_b32 v160, v139, v137, s30
    v_perm_b32 v161, v143, v141, s30
    v_perm_b32 v162, v147, v145, s30
    v_perm_b32 v163, v151, v149, s30
    v_perm_b32 v164, v139, v137, s31
    v_perm_b32 v165, v143, v141, s31
    v_perm_b32 v166, v147, v145, s31
    v_perm_b32 v167, v151, v149, s31
    v_cmp_gt_u32 vcc, 60, v1
    s_and_saveexec_b64 s[34:35], vcc
    buffer_store_dwordx4 v[152:155], v8, s[20:23], s32 offen offset:0
    buffer_store_dwordx4 v[156:159], v8, s[20:23], s32 offen offset:16
    buffer_store_dwordx4 v[160:163], v8, s[20:23], s32 offen offset:32
    buffer_store_dwordx4 v[164:167], v8, s[20:23], s32 offen offset:48
K2_END:
    s_endpgm
.section .rodata,"a"
.p2align 6
.amdhsa_kernel k2_kernel
  .amdhsa_next_free_vgpr 256
  .amdhsa_next_free_sgpr 102
  .amdhsa_accum_offset 256
  .amdhsa_group_segment_fixed_size 0
  .amdhsa_kernarg_size 88
  .amdhsa_user_sgpr_count 2
  .amdhsa_user_sgpr_kernarg_segment_ptr 1
  .amdhsa_system_sgpr_workgroup_id_x 1
.end_amdhsa_kernel
.text
.globl k3_kernel
.p2align 8
.type k3_kernel,@function
k3_kernel:
    s_cmp_ge_u32 s2, 256
    s_cbranch_scc1 K3_END
    s_load_dwordx2 s[4:5], s[0:1], 0
    s_load_dwordx2 s[6:7], s[0:1], 64
    s_load_dwordx2 s[10:11], s[0:1], 80
    s_and_b32 s27, s2, 7
    s_lshl_b32 s27, s27, 2
    s_bfe_u32 s28, s2, 0x20003
    s_add_u32 s24, s27, s28
    s_lshr_b32 s25, s2, 5
    v_lshrrev_b32 v6, 6, v0
    v_and_b32 v1, 63, v0
    v_and_b32 v2, 15, v0
    v_readfirstlane_b32 s26, v6
    v_lshrrev_b32 v3, 4, v1
    v_lshlrev_b32 v4, 4, v1
    v_add_u32 v5, 4096, v4
    s_mul_i32 s32, s25, 44
    s_mul_i32 s33, s26, 12
    s_add_u32 s32, s32, s33
    s_mul_i32 s27, s32, 5120
    s_add_u32 s27, s27, 20185088
    s_mul_i32 s32, s24, 176
    s_add_u32 s32, s32, s33
    s_lshl_b32 s32, s32, 10
    s_add_u32 s28, s32, 14417920
    s_add_u32 s29, s28, 45056
    s_add_u32 s30, s29, 45056
    s_add_u32 s31, s30, 45056
    s_waitcnt lgkmcnt(0)
    s_mov_b32 s12, s4
    s_and_b32 s13, s5, 0xffff
    s_mov_b32 s14, 2621440
    s_mov_b32 s15, 0x00020000
    s_mov_b32 s16, s6
    s_and_b32 s17, s7, 0xffff
    s_mov_b32 s18, 2621440
    s_mov_b32 s19, 0x00020000
    s_mov_b32 s20, s10
    s_and_b32 s21, s11, 0xffff
    s_mov_b32 s22, 21987328
    s_mov_b32 s23, 0x00020000
    buffer_load_dwordx4 v[20:23], v4, s[20:23], s27 offen offset:0
    buffer_load_dwordx4 v[24:27], v4, s[20:23], s27 offen offset:1024
    buffer_load_dwordx4 v[28:31], v4, s[20:23], s27 offen offset:2048
    buffer_load_dwordx4 v[32:35], v4, s[20:23], s27 offen offset:3072
    buffer_load_dwordx4 v[36:39], v5, s[20:23], s27 offen
    buffer_load_dwordx4 v[40:43], v4, s[20:23], s28 offen
    buffer_load_dwordx4 v[44:47], v4, s[20:23], s29 offen
    buffer_load_dwordx4 v[48:51], v4, s[20:23], s30 offen
    buffer_load_dwordx4 v[52:55], v4, s[20:23], s31 offen
    s_add_u32 s27, s27, 5120
    s_add_u32 s28, s28, 1024
    s_add_u32 s29, s29, 1024
    s_add_u32 s30, s30, 1024
    s_add_u32 s31, s31, 1024
    buffer_load_dwordx4 v[56:59], v4, s[20:23], s27 offen offset:0
    buffer_load_dwordx4 v[60:63], v4, s[20:23], s27 offen offset:1024
    buffer_load_dwordx4 v[64:67], v4, s[20:23], s27 offen offset:2048
    buffer_load_dwordx4 v[68:71], v4, s[20:23], s27 offen offset:3072
    buffer_load_dwordx4 v[72:75], v5, s[20:23], s27 offen
    buffer_load_dwordx4 v[76:79], v4, s[20:23], s28 offen
    buffer_load_dwordx4 v[80:83], v4, s[20:23], s29 offen
    buffer_load_dwordx4 v[84:87], v4, s[20:23], s30 offen
    buffer_load_dwordx4 v[88:91], v4, s[20:23], s31 offen
    s_add_u32 s27, s27, 5120
    s_add_u32 s28, s28, 1024
    s_add_u32 s29, s29, 1024
    s_add_u32 s30, s30, 1024
    s_add_u32 s31, s31, 1024
    buffer_load_dwordx4 v[92:95], v4, s[20:23], s27 offen offset:0
    buffer_load_dwordx4 v[96:99], v4, s[20:23], s27 offen offset:1024
    buffer_load_dwordx4 v[100:103], v4, s[20:23], s27 offen offset:2048
    buffer_load_dwordx4 v[104:107], v4, s[20:23], s27 offen offset:3072
    buffer_load_dwordx4 v[108:111], v5, s[20:23], s27 offen
    buffer_load_dwordx4 v[112:115], v4, s[20:23], s28 offen
    buffer_load_dwordx4 v[116:119], v4, s[20:23], s29 offen
    buffer_load_dwordx4 v[120:123], v4, s[20:23], s30 offen
    buffer_load_dwordx4 v[124:127], v4, s[20:23], s31 offen
    s_add_u32 s27, s27, 5120
    s_add_u32 s28, s28, 1024
    s_add_u32 s29, s29, 1024
    s_add_u32 s30, s30, 1024
    s_add_u32 s31, s31, 1024
    buffer_load_dwordx4 v[128:131], v4, s[20:23], s27 offen offset:0
    buffer_load_dwordx4 v[132:135], v4, s[20:23], s27 offen offset:1024
    buffer_load_dwordx4 v[136:139], v4, s[20:23], s27 offen offset:2048
    buffer_load_dwordx4 v[140:143], v4, s[20:23], s27 offen offset:3072
    buffer_load_dwordx4 v[144:147], v5, s[20:23], s27 offen
    buffer_load_dwordx4 v[148:151], v4, s[20:23], s28 offen
    buffer_load_dwordx4 v[152:155], v4, s[20:23], s29 offen
    buffer_load_dwordx4 v[156:159], v4, s[20:23], s30 offen
    buffer_load_dwordx4 v[160:163], v4, s[20:23], s31 offen
    s_add_u32 s27, s27, 5120
    s_add_u32 s28, s28, 1024
    s_add_u32 s29, s29, 1024
    s_add_u32 s30, s30, 1024
    s_add_u32 s31, s31, 1024
    s_lshl_b32 s32, s24, 6
    s_lshl_b32 s33, s26, 4
    s_add_u32 s32, s32, s33
    v_add_u32 v6, s32, v2
    v_mul_u32_u24 v6, 1280, v6
    v_mul_u32_u24 v7, 40, v3
    v_add_u32 v6, v6, v7
    s_mul_i32 s34, s25, 160
    v_mov_b32 v164, 0
    v_mov_b32 v165, 0
    v_mov_b32 v166, 0
    v_mov_b32 v167, 0
    v_mov_b32 v168, 0
    v_mov_b32 v169, 0
    v_mov_b32 v170, 0
    v_mov_b32 v171, 0
    v_mov_b32 v172, 0
    v_mov_b32 v173, 0
    v_mov_b32 v174, 0
    v_mov_b32 v175, 0
    v_mov_b32 v176, 0
    v_mov_b32 v177, 0
    v_mov_b32 v178, 0
    v_mov_b32 v179, 0
    v_mov_b32 v180, 0
    v_mov_b32 v181, 0
    v_mov_b32 v182, 0
    v_mov_b32 v183, 0
    v_mov_b32 v184, 0
    v_mov_b32 v185, 0
    v_mov_b32 v186, 0
    v_mov_b32 v187, 0
    v_mov_b32 v188, 0
    v_mov_b32 v189, 0
    v_mov_b32 v190, 0
    v_mov_b32 v191, 0
    v_mov_b32 v192, 0
    v_mov_b32 v193, 0
    v_mov_b32 v194, 0
    v_mov_b32 v195, 0
    v_mov_b32 v196, 0
    v_mov_b32 v197, 0
    v_mov_b32 v198, 0
    v_mov_b32 v199, 0
    v_mov_b32 v200, 0
    v_mov_b32 v201, 0
    v_mov_b32 v202, 0
    v_mov_b32 v203, 0
    v_mov_b32 v204, 0
    v_mov_b32 v205, 0
    v_mov_b32 v206, 0
    v_mov_b32 v207, 0
    v_mov_b32 v208, 0
    v_mov_b32 v209, 0
    v_mov_b32 v210, 0
    v_mov_b32 v211, 0
    v_mov_b32 v212, 0
    v_mov_b32 v213, 0
    v_mov_b32 v214, 0
    v_mov_b32 v215, 0
    v_mov_b32 v216, 0
    v_mov_b32 v217, 0
    v_mov_b32 v218, 0
    v_mov_b32 v219, 0
    v_mov_b32 v220, 0
    v_mov_b32 v221, 0
    v_mov_b32 v222, 0
    v_mov_b32 v223, 0
    v_mov_b32 v224, 0
    v_mov_b32 v225, 0
    v_mov_b32 v226, 0
    v_mov_b32 v227, 0
    v_mov_b32 v228, 0
    v_mov_b32 v229, 0
    v_mov_b32 v230, 0
    v_mov_b32 v231, 0
    v_mov_b32 v232, 0
    v_mov_b32 v233, 0
    v_mov_b32 v234, 0
    v_mov_b32 v235, 0
    v_mov_b32 v236, 0
    v_mov_b32 v237, 0
    v_mov_b32 v238, 0
    v_mov_b32 v239, 0
    v_mov_b32 v240, 0
    v_mov_b32 v241, 0
    v_mov_b32 v242, 0
    v_mov_b32 v243, 0
    s_cmp_eq_u32 s26, 3
    s_cselect_b32 s35, 1, 2
K3_LOOP:
    s_waitcnt vmcnt(27)
    v_mfma_f32_16x16x32_bf16 v[164:167], v[20:23], v[40:43], v[164:167]
    v_mfma_f32_16x16x32_bf16 v[168:171], v[20:23], v[44:47], v[168:171]
    v_mfma_f32_16x16x32_bf16 v[172:175], v[20:23], v[48:51], v[172:175]
    v_mfma_f32_16x16x32_bf16 v[176:179], v[20:23], v[52:55], v[176:179]
    v_mfma_f32_16x16x32_bf16 v[180:183], v[24:27], v[40:43], v[180:183]
    v_mfma_f32_16x16x32_bf16 v[184:187], v[24:27], v[44:47], v[184:187]
    v_mfma_f32_16x16x32_bf16 v[188:191], v[24:27], v[48:51], v[188:191]
    v_mfma_f32_16x16x32_bf16 v[192:195], v[24:27], v[52:55], v[192:195]
    v_mfma_f32_16x16x32_bf16 v[196:199], v[28:31], v[40:43], v[196:199]
    v_mfma_f32_16x16x32_bf16 v[200:203], v[28:31], v[44:47], v[200:203]
    v_mfma_f32_16x16x32_bf16 v[204:207], v[28:31], v[48:51], v[204:207]
    v_mfma_f32_16x16x32_bf16 v[208:211], v[28:31], v[52:55], v[208:211]
    v_mfma_f32_16x16x32_bf16 v[212:215], v[32:35], v[40:43], v[212:215]
    v_mfma_f32_16x16x32_bf16 v[216:219], v[32:35], v[44:47], v[216:219]
    v_mfma_f32_16x16x32_bf16 v[220:223], v[32:35], v[48:51], v[220:223]
    v_mfma_f32_16x16x32_bf16 v[224:227], v[32:35], v[52:55], v[224:227]
    v_mfma_f32_16x16x32_bf16 v[228:231], v[36:39], v[40:43], v[228:231]
    v_mfma_f32_16x16x32_bf16 v[232:235], v[36:39], v[44:47], v[232:235]
    v_mfma_f32_16x16x32_bf16 v[236:239], v[36:39], v[48:51], v[236:239]
    v_mfma_f32_16x16x32_bf16 v[240:243], v[36:39], v[52:55], v[240:243]
    buffer_load_dwordx4 v[20:23], v4, s[20:23], s27 offen offset:0
    buffer_load_dwordx4 v[24:27], v4, s[20:23], s27 offen offset:1024
    buffer_load_dwordx4 v[28:31], v4, s[20:23], s27 offen offset:2048
    buffer_load_dwordx4 v[32:35], v4, s[20:23], s27 offen offset:3072
    buffer_load_dwordx4 v[36:39], v5, s[20:23], s27 offen
    buffer_load_dwordx4 v[40:43], v4, s[20:23], s28 offen
    buffer_load_dwordx4 v[44:47], v4, s[20:23], s29 offen
    buffer_load_dwordx4 v[48:51], v4, s[20:23], s30 offen
    buffer_load_dwordx4 v[52:55], v4, s[20:23], s31 offen
    s_add_u32 s27, s27, 5120
    s_add_u32 s28, s28, 1024
    s_add_u32 s29, s29, 1024
    s_add_u32 s30, s30, 1024
    s_add_u32 s31, s31, 1024
    s_waitcnt vmcnt(27)
    v_mfma_f32_16x16x32_bf16 v[164:167], v[56:59], v[76:79], v[164:167]
    v_mfma_f32_16x16x32_bf16 v[168:171], v[56:59], v[80:83], v[168:171]
    v_mfma_f32_16x16x32_bf16 v[172:175], v[56:59], v[84:87], v[172:175]
    v_mfma_f32_16x16x32_bf16 v[176:179], v[56:59], v[88:91], v[176:179]
    v_mfma_f32_16x16x32_bf16 v[180:183], v[60:63], v[76:79], v[180:183]
    v_mfma_f32_16x16x32_bf16 v[184:187], v[60:63], v[80:83], v[184:187]
    v_mfma_f32_16x16x32_bf16 v[188:191], v[60:63], v[84:87], v[188:191]
    v_mfma_f32_16x16x32_bf16 v[192:195], v[60:63], v[88:91], v[192:195]
    v_mfma_f32_16x16x32_bf16 v[196:199], v[64:67], v[76:79], v[196:199]
    v_mfma_f32_16x16x32_bf16 v[200:203], v[64:67], v[80:83], v[200:203]
    v_mfma_f32_16x16x32_bf16 v[204:207], v[64:67], v[84:87], v[204:207]
    v_mfma_f32_16x16x32_bf16 v[208:211], v[64:67], v[88:91], v[208:211]
    v_mfma_f32_16x16x32_bf16 v[212:215], v[68:71], v[76:79], v[212:215]
    v_mfma_f32_16x16x32_bf16 v[216:219], v[68:71], v[80:83], v[216:219]
    v_mfma_f32_16x16x32_bf16 v[220:223], v[68:71], v[84:87], v[220:223]
    v_mfma_f32_16x16x32_bf16 v[224:227], v[68:71], v[88:91], v[224:227]
    v_mfma_f32_16x16x32_bf16 v[228:231], v[72:75], v[76:79], v[228:231]
    v_mfma_f32_16x16x32_bf16 v[232:235], v[72:75], v[80:83], v[232:235]
    v_mfma_f32_16x16x32_bf16 v[236:239], v[72:75], v[84:87], v[236:239]
    v_mfma_f32_16x16x32_bf16 v[240:243], v[72:75], v[88:91], v[240:243]
    buffer_load_dwordx4 v[56:59], v4, s[20:23], s27 offen offset:0
    buffer_load_dwordx4 v[60:63], v4, s[20:23], s27 offen offset:1024
    buffer_load_dwordx4 v[64:67], v4, s[20:23], s27 offen offset:2048
    buffer_load_dwordx4 v[68:71], v4, s[20:23], s27 offen offset:3072
    buffer_load_dwordx4 v[72:75], v5, s[20:23], s27 offen
    buffer_load_dwordx4 v[76:79], v4, s[20:23], s28 offen
    buffer_load_dwordx4 v[80:83], v4, s[20:23], s29 offen
    buffer_load_dwordx4 v[84:87], v4, s[20:23], s30 offen
    buffer_load_dwordx4 v[88:91], v4, s[20:23], s31 offen
    s_add_u32 s27, s27, 5120
    s_add_u32 s28, s28, 1024
    s_add_u32 s29, s29, 1024
    s_add_u32 s30, s30, 1024
    s_add_u32 s31, s31, 1024
    s_waitcnt vmcnt(27)
    v_mfma_f32_16x16x32_bf16 v[164:167], v[92:95], v[112:115], v[164:167]
    v_mfma_f32_16x16x32_bf16 v[168:171], v[92:95], v[116:119], v[168:171]
    v_mfma_f32_16x16x32_bf16 v[172:175], v[92:95], v[120:123], v[172:175]
    v_mfma_f32_16x16x32_bf16 v[176:179], v[92:95], v[124:127], v[176:179]
    v_mfma_f32_16x16x32_bf16 v[180:183], v[96:99], v[112:115], v[180:183]
    v_mfma_f32_16x16x32_bf16 v[184:187], v[96:99], v[116:119], v[184:187]
    v_mfma_f32_16x16x32_bf16 v[188:191], v[96:99], v[120:123], v[188:191]
    v_mfma_f32_16x16x32_bf16 v[192:195], v[96:99], v[124:127], v[192:195]
    v_mfma_f32_16x16x32_bf16 v[196:199], v[100:103], v[112:115], v[196:199]
    v_mfma_f32_16x16x32_bf16 v[200:203], v[100:103], v[116:119], v[200:203]
    v_mfma_f32_16x16x32_bf16 v[204:207], v[100:103], v[120:123], v[204:207]
    v_mfma_f32_16x16x32_bf16 v[208:211], v[100:103], v[124:127], v[208:211]
    v_mfma_f32_16x16x32_bf16 v[212:215], v[104:107], v[112:115], v[212:215]
    v_mfma_f32_16x16x32_bf16 v[216:219], v[104:107], v[116:119], v[216:219]
    v_mfma_f32_16x16x32_bf16 v[220:223], v[104:107], v[120:123], v[220:223]
    v_mfma_f32_16x16x32_bf16 v[224:227], v[104:107], v[124:127], v[224:227]
    v_mfma_f32_16x16x32_bf16 v[228:231], v[108:111], v[112:115], v[228:231]
    v_mfma_f32_16x16x32_bf16 v[232:235], v[108:111], v[116:119], v[232:235]
    v_mfma_f32_16x16x32_bf16 v[236:239], v[108:111], v[120:123], v[236:239]
    v_mfma_f32_16x16x32_bf16 v[240:243], v[108:111], v[124:127], v[240:243]
    buffer_load_dwordx4 v[92:95], v4, s[20:23], s27 offen offset:0
    buffer_load_dwordx4 v[96:99], v4, s[20:23], s27 offen offset:1024
    buffer_load_dwordx4 v[100:103], v4, s[20:23], s27 offen offset:2048
    buffer_load_dwordx4 v[104:107], v4, s[20:23], s27 offen offset:3072
    buffer_load_dwordx4 v[108:111], v5, s[20:23], s27 offen
    buffer_load_dwordx4 v[112:115], v4, s[20:23], s28 offen
    buffer_load_dwordx4 v[116:119], v4, s[20:23], s29 offen
    buffer_load_dwordx4 v[120:123], v4, s[20:23], s30 offen
    buffer_load_dwordx4 v[124:127], v4, s[20:23], s31 offen
    s_add_u32 s27, s27, 5120
    s_add_u32 s28, s28, 1024
    s_add_u32 s29, s29, 1024
    s_add_u32 s30, s30, 1024
    s_add_u32 s31, s31, 1024
    s_waitcnt vmcnt(27)
    v_mfma_f32_16x16x32_bf16 v[164:167], v[128:131], v[148:151], v[164:167]
    v_mfma_f32_16x16x32_bf16 v[168:171], v[128:131], v[152:155], v[168:171]
    v_mfma_f32_16x16x32_bf16 v[172:175], v[128:131], v[156:159], v[172:175]
    v_mfma_f32_16x16x32_bf16 v[176:179], v[128:131], v[160:163], v[176:179]
    v_mfma_f32_16x16x32_bf16 v[180:183], v[132:135], v[148:151], v[180:183]
    v_mfma_f32_16x16x32_bf16 v[184:187], v[132:135], v[152:155], v[184:187]
    v_mfma_f32_16x16x32_bf16 v[188:191], v[132:135], v[156:159], v[188:191]
    v_mfma_f32_16x16x32_bf16 v[192:195], v[132:135], v[160:163], v[192:195]
    v_mfma_f32_16x16x32_bf16 v[196:199], v[136:139], v[148:151], v[196:199]
    v_mfma_f32_16x16x32_bf16 v[200:203], v[136:139], v[152:155], v[200:203]
    v_mfma_f32_16x16x32_bf16 v[204:207], v[136:139], v[156:159], v[204:207]
    v_mfma_f32_16x16x32_bf16 v[208:211], v[136:139], v[160:163], v[208:211]
    v_mfma_f32_16x16x32_bf16 v[212:215], v[140:143], v[148:151], v[212:215]
    v_mfma_f32_16x16x32_bf16 v[216:219], v[140:143], v[152:155], v[216:219]
    v_mfma_f32_16x16x32_bf16 v[220:223], v[140:143], v[156:159], v[220:223]
    v_mfma_f32_16x16x32_bf16 v[224:227], v[140:143], v[160:163], v[224:227]
    v_mfma_f32_16x16x32_bf16 v[228:231], v[144:147], v[148:151], v[228:231]
    v_mfma_f32_16x16x32_bf16 v[232:235], v[144:147], v[152:155], v[232:235]
    v_mfma_f32_16x16x32_bf16 v[236:239], v[144:147], v[156:159], v[236:239]
    v_mfma_f32_16x16x32_bf16 v[240:243], v[144:147], v[160:163], v[240:243]
    buffer_load_dwordx4 v[128:131], v4, s[20:23], s27 offen offset:0
    buffer_load_dwordx4 v[132:135], v4, s[20:23], s27 offen offset:1024
    buffer_load_dwordx4 v[136:139], v4, s[20:23], s27 offen offset:2048
    buffer_load_dwordx4 v[140:143], v4, s[20:23], s27 offen offset:3072
    buffer_load_dwordx4 v[144:147], v5, s[20:23], s27 offen
    buffer_load_dwordx4 v[148:151], v4, s[20:23], s28 offen
    buffer_load_dwordx4 v[152:155], v4, s[20:23], s29 offen
    buffer_load_dwordx4 v[156:159], v4, s[20:23], s30 offen
    buffer_load_dwordx4 v[160:163], v4, s[20:23], s31 offen
    s_add_u32 s27, s27, 5120
    s_add_u32 s28, s28, 1024
    s_add_u32 s29, s29, 1024
    s_add_u32 s30, s30, 1024
    s_add_u32 s31, s31, 1024
    s_sub_u32 s35, s35, 1
    s_cmp_lg_u32 s35, 0
    s_cbranch_scc1 K3_LOOP
    buffer_load_dwordx2 v[8:9], v6, s[12:15], s34 offen offset:0
    buffer_load_dwordx2 v[10:11], v6, s[12:15], s34 offen offset:8
    buffer_load_dwordx2 v[12:13], v6, s[12:15], s34 offen offset:16
    buffer_load_dwordx2 v[14:15], v6, s[12:15], s34 offen offset:24
    buffer_load_dwordx2 v[16:17], v6, s[12:15], s34 offen offset:32
    s_waitcnt vmcnt(32)
    v_mfma_f32_16x16x32_bf16 v[164:167], v[20:23], v[40:43], v[164:167]
    v_mfma_f32_16x16x32_bf16 v[168:171], v[20:23], v[44:47], v[168:171]
    v_mfma_f32_16x16x32_bf16 v[172:175], v[20:23], v[48:51], v[172:175]
    v_mfma_f32_16x16x32_bf16 v[176:179], v[20:23], v[52:55], v[176:179]
    v_mfma_f32_16x16x32_bf16 v[180:183], v[24:27], v[40:43], v[180:183]
    v_mfma_f32_16x16x32_bf16 v[184:187], v[24:27], v[44:47], v[184:187]
    v_mfma_f32_16x16x32_bf16 v[188:191], v[24:27], v[48:51], v[188:191]
    v_mfma_f32_16x16x32_bf16 v[192:195], v[24:27], v[52:55], v[192:195]
    v_mfma_f32_16x16x32_bf16 v[196:199], v[28:31], v[40:43], v[196:199]
    v_mfma_f32_16x16x32_bf16 v[200:203], v[28:31], v[44:47], v[200:203]
    v_mfma_f32_16x16x32_bf16 v[204:207], v[28:31], v[48:51], v[204:207]
    v_mfma_f32_16x16x32_bf16 v[208:211], v[28:31], v[52:55], v[208:211]
    v_mfma_f32_16x16x32_bf16 v[212:215], v[32:35], v[40:43], v[212:215]
    v_mfma_f32_16x16x32_bf16 v[216:219], v[32:35], v[44:47], v[216:219]
    v_mfma_f32_16x16x32_bf16 v[220:223], v[32:35], v[48:51], v[220:223]
    v_mfma_f32_16x16x32_bf16 v[224:227], v[32:35], v[52:55], v[224:227]
    v_mfma_f32_16x16x32_bf16 v[228:231], v[36:39], v[40:43], v[228:231]
    v_mfma_f32_16x16x32_bf16 v[232:235], v[36:39], v[44:47], v[232:235]
    v_mfma_f32_16x16x32_bf16 v[236:239], v[36:39], v[48:51], v[236:239]
    v_mfma_f32_16x16x32_bf16 v[240:243], v[36:39], v[52:55], v[240:243]
    s_waitcnt vmcnt(23)
    v_mfma_f32_16x16x32_bf16 v[164:167], v[56:59], v[76:79], v[164:167]
    v_mfma_f32_16x16x32_bf16 v[168:171], v[56:59], v[80:83], v[168:171]
    v_mfma_f32_16x16x32_bf16 v[172:175], v[56:59], v[84:87], v[172:175]
    v_mfma_f32_16x16x32_bf16 v[176:179], v[56:59], v[88:91], v[176:179]
    v_mfma_f32_16x16x32_bf16 v[180:183], v[60:63], v[76:79], v[180:183]
    v_mfma_f32_16x16x32_bf16 v[184:187], v[60:63], v[80:83], v[184:187]
    v_mfma_f32_16x16x32_bf16 v[188:191], v[60:63], v[84:87], v[188:191]
    v_mfma_f32_16x16x32_bf16 v[192:195], v[60:63], v[88:91], v[192:195]
    v_mfma_f32_16x16x32_bf16 v[196:199], v[64:67], v[76:79], v[196:199]
    v_mfma_f32_16x16x32_bf16 v[200:203], v[64:67], v[80:83], v[200:203]
    v_mfma_f32_16x16x32_bf16 v[204:207], v[64:67], v[84:87], v[204:207]
    v_mfma_f32_16x16x32_bf16 v[208:211], v[64:67], v[88:91], v[208:211]
    v_mfma_f32_16x16x32_bf16 v[212:215], v[68:71], v[76:79], v[212:215]
    v_mfma_f32_16x16x32_bf16 v[216:219], v[68:71], v[80:83], v[216:219]
    v_mfma_f32_16x16x32_bf16 v[220:223], v[68:71], v[84:87], v[220:223]
    v_mfma_f32_16x16x32_bf16 v[224:227], v[68:71], v[88:91], v[224:227]
    v_mfma_f32_16x16x32_bf16 v[228:231], v[72:75], v[76:79], v[228:231]
    v_mfma_f32_16x16x32_bf16 v[232:235], v[72:75], v[80:83], v[232:235]
    v_mfma_f32_16x16x32_bf16 v[236:239], v[72:75], v[84:87], v[236:239]
    v_mfma_f32_16x16x32_bf16 v[240:243], v[72:75], v[88:91], v[240:243]
    s_waitcnt vmcnt(14)
    v_mfma_f32_16x16x32_bf16 v[164:167], v[92:95], v[112:115], v[164:167]
    v_mfma_f32_16x16x32_bf16 v[168:171], v[92:95], v[116:119], v[168:171]
    v_mfma_f32_16x16x32_bf16 v[172:175], v[92:95], v[120:123], v[172:175]
    v_mfma_f32_16x16x32_bf16 v[176:179], v[92:95], v[124:127], v[176:179]
    v_mfma_f32_16x16x32_bf16 v[180:183], v[96:99], v[112:115], v[180:183]
    v_mfma_f32_16x16x32_bf16 v[184:187], v[96:99], v[116:119], v[184:187]
    v_mfma_f32_16x16x32_bf16 v[188:191], v[96:99], v[120:123], v[188:191]
    v_mfma_f32_16x16x32_bf16 v[192:195], v[96:99], v[124:127], v[192:195]
    v_mfma_f32_16x16x32_bf16 v[196:199], v[100:103], v[112:115], v[196:199]
    v_mfma_f32_16x16x32_bf16 v[200:203], v[100:103], v[116:119], v[200:203]
    v_mfma_f32_16x16x32_bf16 v[204:207], v[100:103], v[120:123], v[204:207]
    v_mfma_f32_16x16x32_bf16 v[208:211], v[100:103], v[124:127], v[208:211]
    v_mfma_f32_16x16x32_bf16 v[212:215], v[104:107], v[112:115], v[212:215]
    v_mfma_f32_16x16x32_bf16 v[216:219], v[104:107], v[116:119], v[216:219]
    v_mfma_f32_16x16x32_bf16 v[220:223], v[104:107], v[120:123], v[220:223]
    v_mfma_f32_16x16x32_bf16 v[224:227], v[104:107], v[124:127], v[224:227]
    v_mfma_f32_16x16x32_bf16 v[228:231], v[108:111], v[112:115], v[228:231]
    v_mfma_f32_16x16x32_bf16 v[232:235], v[108:111], v[116:119], v[232:235]
    v_mfma_f32_16x16x32_bf16 v[236:239], v[108:111], v[120:123], v[236:239]
    v_mfma_f32_16x16x32_bf16 v[240:243], v[108:111], v[124:127], v[240:243]
    s_waitcnt vmcnt(5)
    v_mfma_f32_16x16x32_bf16 v[164:167], v[128:131], v[148:151], v[164:167]
    v_mfma_f32_16x16x32_bf16 v[168:171], v[128:131], v[152:155], v[168:171]
    v_mfma_f32_16x16x32_bf16 v[172:175], v[128:131], v[156:159], v[172:175]
    v_mfma_f32_16x16x32_bf16 v[176:179], v[128:131], v[160:163], v[176:179]
    v_mfma_f32_16x16x32_bf16 v[180:183], v[132:135], v[148:151], v[180:183]
    v_mfma_f32_16x16x32_bf16 v[184:187], v[132:135], v[152:155], v[184:187]
    v_mfma_f32_16x16x32_bf16 v[188:191], v[132:135], v[156:159], v[188:191]
    v_mfma_f32_16x16x32_bf16 v[192:195], v[132:135], v[160:163], v[192:195]
    v_mfma_f32_16x16x32_bf16 v[196:199], v[136:139], v[148:151], v[196:199]
    v_mfma_f32_16x16x32_bf16 v[200:203], v[136:139], v[152:155], v[200:203]
    v_mfma_f32_16x16x32_bf16 v[204:207], v[136:139], v[156:159], v[204:207]
    v_mfma_f32_16x16x32_bf16 v[208:211], v[136:139], v[160:163], v[208:211]
    v_mfma_f32_16x16x32_bf16 v[212:215], v[140:143], v[148:151], v[212:215]
    v_mfma_f32_16x16x32_bf16 v[216:219], v[140:143], v[152:155], v[216:219]
    v_mfma_f32_16x16x32_bf16 v[220:223], v[140:143], v[156:159], v[220:223]
    v_mfma_f32_16x16x32_bf16 v[224:227], v[140:143], v[160:163], v[224:227]
    v_mfma_f32_16x16x32_bf16 v[228:231], v[144:147], v[148:151], v[228:231]
    v_mfma_f32_16x16x32_bf16 v[232:235], v[144:147], v[152:155], v[232:235]
    v_mfma_f32_16x16x32_bf16 v[236:239], v[144:147], v[156:159], v[236:239]
    v_mfma_f32_16x16x32_bf16 v[240:243], v[144:147], v[160:163], v[240:243]
    s_nop 7
    s_mul_i32 s35, s26, 5120
    v_add_u32 v7, s35, v4
    s_cmp_eq_u32 s26, 0
    s_cbranch_scc1 K3_SK_2001
    ds_write_b128 v7, v[164:167] offset:0
    ds_write_b128 v7, v[180:183] offset:1024
    ds_write_b128 v7, v[196:199] offset:2048
    ds_write_b128 v7, v[212:215] offset:3072
    ds_write_b128 v7, v[228:231] offset:4096
K3_SK_2001:
    v_add_u32 v7, 20480, v7
    s_cmp_eq_u32 s26, 1
    s_cbranch_scc1 K3_SK_2002
    ds_write_b128 v7, v[168:171] offset:0
    ds_write_b128 v7, v[184:187] offset:1024
    ds_write_b128 v7, v[200:203] offset:2048
    ds_write_b128 v7, v[216:219] offset:3072
    ds_write_b128 v7, v[232:235] offset:4096
K3_SK_2002:
    v_add_u32 v7, 20480, v7
    s_cmp_eq_u32 s26, 2
    s_cbranch_scc1 K3_SK_2003
    ds_write_b128 v7, v[172:175] offset:0
    ds_write_b128 v7, v[188:191] offset:1024
    ds_write_b128 v7, v[204:207] offset:2048
    ds_write_b128 v7, v[220:223] offset:3072
    ds_write_b128 v7, v[236:239] offset:4096
K3_SK_2003:
    v_add_u32 v7, 20480, v7
    s_cmp_eq_u32 s26, 3
    s_cbranch_scc1 K3_SK_2004
    ds_write_b128 v7, v[176:179] offset:0
    ds_write_b128 v7, v[192:195] offset:1024
    ds_write_b128 v7, v[208:211] offset:2048
    ds_write_b128 v7, v[224:227] offset:3072
    ds_write_b128 v7, v[240:243] offset:4096
K3_SK_2004:
    v_add_u32 v7, 20480, v7
    s_cmp_lg_u32 s26, 0
    s_cbranch_scc1 K3_MV_2005
    v_mov_b32 v20, v164
    v_mov_b32 v21, v165
    v_mov_b32 v22, v166
    v_mov_b32 v23, v167
    v_mov_b32 v24, v180
    v_mov_b32 v25, v181
    v_mov_b32 v26, v182
    v_mov_b32 v27, v183
    v_mov_b32 v28, v196
    v_mov_b32 v29, v197
    v_mov_b32 v30, v198
    v_mov_b32 v31, v199
    v_mov_b32 v32, v212
    v_mov_b32 v33, v213
    v_mov_b32 v34, v214
    v_mov_b32 v35, v215
    v_mov_b32 v36, v228
    v_mov_b32 v37, v229
    v_mov_b32 v38, v230
    v_mov_b32 v39, v231
K3_MV_2005:
    s_cmp_lg_u32 s26, 1
    s_cbranch_scc1 K3_MV_2006
    v_mov_b32 v20, v168
    v_mov_b32 v21, v169
    v_mov_b32 v22, v170
    v_mov_b32 v23, v171
    v_mov_b32 v24, v184
    v_mov_b32 v25, v185
    v_mov_b32 v26, v186
    v_mov_b32 v27, v187
    v_mov_b32 v28, v200
    v_mov_b32 v29, v201
    v_mov_b32 v30, v202
    v_mov_b32 v31, v203
    v_mov_b32 v32, v216
    v_mov_b32 v33, v217
    v_mov_b32 v34, v218
    v_mov_b32 v35, v219
    v_mov_b32 v36, v232
    v_mov_b32 v37, v233
    v_mov_b32 v38, v234
    v_mov_b32 v39, v235
K3_MV_2006:
    s_cmp_lg_u32 s26, 2
    s_cbranch_scc1 K3_MV_2007
    v_mov_b32 v20, v172
    v_mov_b32 v21, v173
    v_mov_b32 v22, v174
    v_mov_b32 v23, v175
    v_mov_b32 v24, v188
    v_mov_b32 v25, v189
    v_mov_b32 v26, v190
    v_mov_b32 v27, v191
    v_mov_b32 v28, v204
    v_mov_b32 v29, v205
    v_mov_b32 v30, v206
    v_mov_b32 v31, v207
    v_mov_b32 v32, v220
    v_mov_b32 v33, v221
    v_mov_b32 v34, v222
    v_mov_b32 v35, v223
    v_mov_b32 v36, v236
    v_mov_b32 v37, v237
    v_mov_b32 v38, v238
    v_mov_b32 v39, v239
K3_MV_2007:
    s_cmp_lg_u32 s26, 3
    s_cbranch_scc1 K3_MV_2008
    v_mov_b32 v20, v176
    v_mov_b32 v21, v177
    v_mov_b32 v22, v178
    v_mov_b32 v23, v179
    v_mov_b32 v24, v192
    v_mov_b32 v25, v193
    v_mov_b32 v26, v194
    v_mov_b32 v27, v195
    v_mov_b32 v28, v208
    v_mov_b32 v29, v209
    v_mov_b32 v30, v210
    v_mov_b32 v31, v211
    v_mov_b32 v32, v224
    v_mov_b32 v33, v225
    v_mov_b32 v34, v226
    v_mov_b32 v35, v227
    v_mov_b32 v36, v240
    v_mov_b32 v37, v241
    v_mov_b32 v38, v242
    v_mov_b32 v39, v243
K3_MV_2008:
    s_waitcnt lgkmcnt(0)
    s_barrier
    s_mul_i32 s35, s26, 20480
    v_add_u32 v7, s35, v4
    s_cmp_eq_u32 s26, 0
    s_cbranch_scc1 K3_RD_2009
    ds_read_b128 v[40:43], v7 offset:0
    ds_read_b128 v[44:47], v7 offset:1024
    ds_read_b128 v[48:51], v7 offset:2048
    ds_read_b128 v[52:55], v7 offset:3072
    ds_read_b128 v[56:59], v7 offset:4096
    s_waitcnt lgkmcnt(0)
    v_add_f32 v20, v20, v40
    v_add_f32 v21, v21, v41
    v_add_f32 v22, v22, v42
    v_add_f32 v23, v23, v43
    v_add_f32 v24, v24, v44
    v_add_f32 v25, v25, v45
    v_add_f32 v26, v26, v46
    v_add_f32 v27, v27, v47
    v_add_f32 v28, v28, v48
    v_add_f32 v29, v29, v49
    v_add_f32 v30, v30, v50
    v_add_f32 v31, v31, v51
    v_add_f32 v32, v32, v52
    v_add_f32 v33, v33, v53
    v_add_f32 v34, v34, v54
    v_add_f32 v35, v35, v55
    v_add_f32 v36, v36, v56
    v_add_f32 v37, v37, v57
    v_add_f32 v38, v38, v58
    v_add_f32 v39, v39, v59
K3_RD_2009:
    s_cmp_eq_u32 s26, 1
    s_cbranch_scc1 K3_RD_2010
    ds_read_b128 v[40:43], v7 offset:5120
    ds_read_b128 v[44:47], v7 offset:6144
    ds_read_b128 v[48:51], v7 offset:7168
    ds_read_b128 v[52:55], v7 offset:8192
    ds_read_b128 v[56:59], v7 offset:9216
    s_waitcnt lgkmcnt(0)
    v_add_f32 v20, v20, v40
    v_add_f32 v21, v21, v41
    v_add_f32 v22, v22, v42
    v_add_f32 v23, v23, v43
    v_add_f32 v24, v24, v44
    v_add_f32 v25, v25, v45
    v_add_f32 v26, v26, v46
    v_add_f32 v27, v27, v47
    v_add_f32 v28, v28, v48
    v_add_f32 v29, v29, v49
    v_add_f32 v30, v30, v50
    v_add_f32 v31, v31, v51
    v_add_f32 v32, v32, v52
    v_add_f32 v33, v33, v53
    v_add_f32 v34, v34, v54
    v_add_f32 v35, v35, v55
    v_add_f32 v36, v36, v56
    v_add_f32 v37, v37, v57
    v_add_f32 v38, v38, v58
    v_add_f32 v39, v39, v59
K3_RD_2010:
    s_cmp_eq_u32 s26, 2
    s_cbranch_scc1 K3_RD_2011
    ds_read_b128 v[40:43], v7 offset:10240
    ds_read_b128 v[44:47], v7 offset:11264
    ds_read_b128 v[48:51], v7 offset:12288
    ds_read_b128 v[52:55], v7 offset:13312
    ds_read_b128 v[56:59], v7 offset:14336
    s_waitcnt lgkmcnt(0)
    v_add_f32 v20, v20, v40
    v_add_f32 v21, v21, v41
    v_add_f32 v22, v22, v42
    v_add_f32 v23, v23, v43
    v_add_f32 v24, v24, v44
    v_add_f32 v25, v25, v45
    v_add_f32 v26, v26, v46
    v_add_f32 v27, v27, v47
    v_add_f32 v28, v28, v48
    v_add_f32 v29, v29, v49
    v_add_f32 v30, v30, v50
    v_add_f32 v31, v31, v51
    v_add_f32 v32, v32, v52
    v_add_f32 v33, v33, v53
    v_add_f32 v34, v34, v54
    v_add_f32 v35, v35, v55
    v_add_f32 v36, v36, v56
    v_add_f32 v37, v37, v57
    v_add_f32 v38, v38, v58
    v_add_f32 v39, v39, v59
K3_RD_2011:
    s_cmp_eq_u32 s26, 3
    s_cbranch_scc1 K3_RD_2012
    ds_read_b128 v[40:43], v7 offset:15360
    ds_read_b128 v[44:47], v7 offset:16384
    ds_read_b128 v[48:51], v7 offset:17408
    ds_read_b128 v[52:55], v7 offset:18432
    ds_read_b128 v[56:59], v7 offset:19456
    s_waitcnt lgkmcnt(0)
    v_add_f32 v20, v20, v40
    v_add_f32 v21, v21, v41
    v_add_f32 v22, v22, v42
    v_add_f32 v23, v23, v43
    v_add_f32 v24, v24, v44
    v_add_f32 v25, v25, v45
    v_add_f32 v26, v26, v46
    v_add_f32 v27, v27, v47
    v_add_f32 v28, v28, v48
    v_add_f32 v29, v29, v49
    v_add_f32 v30, v30, v50
    v_add_f32 v31, v31, v51
    v_add_f32 v32, v32, v52
    v_add_f32 v33, v33, v53
    v_add_f32 v34, v34, v54
    v_add_f32 v35, v35, v55
    v_add_f32 v36, v36, v56
    v_add_f32 v37, v37, v57
    v_add_f32 v38, v38, v58
    v_add_f32 v39, v39, v59
K3_RD_2012:
    s_waitcnt vmcnt(0)
    s_mov_b32 s36, 0xffff0000
    v_lshlrev_b32 v60, 16, v8
    v_and_b32 v61, s36, v8
    v_lshlrev_b32 v62, 16, v9
    v_and_b32 v63, s36, v9
    v_add_f32 v20, v20, v60
    v_add_f32 v21, v21, v61
    v_add_f32 v22, v22, v62
    v_add_f32 v23, v23, v63
    v_cvt_pk_bf16_f32 v64, v20, v21
    v_cvt_pk_bf16_f32 v65, v22, v23
    buffer_store_dwordx2 v[64:65], v6, s[16:19], s34 offen offset:0
    v_lshlrev_b32 v60, 16, v10
    v_and_b32 v61, s36, v10
    v_lshlrev_b32 v62, 16, v11
    v_and_b32 v63, s36, v11
    v_add_f32 v24, v24, v60
    v_add_f32 v25, v25, v61
    v_add_f32 v26, v26, v62
    v_add_f32 v27, v27, v63
    v_cvt_pk_bf16_f32 v66, v24, v25
    v_cvt_pk_bf16_f32 v67, v26, v27
    buffer_store_dwordx2 v[66:67], v6, s[16:19], s34 offen offset:8
    v_lshlrev_b32 v60, 16, v12
    v_and_b32 v61, s36, v12
    v_lshlrev_b32 v62, 16, v13
    v_and_b32 v63, s36, v13
    v_add_f32 v28, v28, v60
    v_add_f32 v29, v29, v61
    v_add_f32 v30, v30, v62
    v_add_f32 v31, v31, v63
    v_cvt_pk_bf16_f32 v68, v28, v29
    v_cvt_pk_bf16_f32 v69, v30, v31
    buffer_store_dwordx2 v[68:69], v6, s[16:19], s34 offen offset:16
    v_lshlrev_b32 v60, 16, v14
    v_and_b32 v61, s36, v14
    v_lshlrev_b32 v62, 16, v15
    v_and_b32 v63, s36, v15
    v_add_f32 v32, v32, v60
    v_add_f32 v33, v33, v61
    v_add_f32 v34, v34, v62
    v_add_f32 v35, v35, v63
    v_cvt_pk_bf16_f32 v70, v32, v33
    v_cvt_pk_bf16_f32 v71, v34, v35
    buffer_store_dwordx2 v[70:71], v6, s[16:19], s34 offen offset:24
    v_lshlrev_b32 v60, 16, v16
    v_and_b32 v61, s36, v16
    v_lshlrev_b32 v62, 16, v17
    v_and_b32 v63, s36, v17
    v_add_f32 v36, v36, v60
    v_add_f32 v37, v37, v61
    v_add_f32 v38, v38, v62
    v_add_f32 v39, v39, v63
    v_cvt_pk_bf16_f32 v72, v36, v37
    v_cvt_pk_bf16_f32 v73, v38, v39
    buffer_store_dwordx2 v[72:73], v6, s[16:19], s34 offen offset:32
    s_waitcnt vmcnt(0)
    s_waitcnt lgkmcnt(0)
K3_END:
    s_endpgm
.section .rodata,"a"
.p2align 6
.amdhsa_kernel k3_kernel
  .amdhsa_next_free_vgpr 256
  .amdhsa_next_free_sgpr 102
  .amdhsa_accum_offset 256
  .amdhsa_group_segment_fixed_size 0
  .amdhsa_kernarg_size 88
  .amdhsa_user_sgpr_count 2
  .amdhsa_user_sgpr_kernarg_segment_ptr 1
  .amdhsa_system_sgpr_workgroup_id_x 1
.end_amdhsa_kernel
.text
```
